```python
import torch

def _softmax(x, axis=-1):
    return torch.softmax(x, dim=axis)
def _gelu(x):
    return torch.nn.functional.gelu(x, approximate="tanh")
def _silu(x):
    return torch.nn.functional.silu(x)
def _sigmoid(x):
    return torch.sigmoid(x)
def _layernorm(x, axis=-1, eps=1e-5):
    m = x.mean(dim=axis, keepdim=True)
    v = x.var(dim=axis, keepdim=True, unbiased=False)
    return (x - m) / torch.sqrt(v + eps)
def _scatter_add(tgt, idx, src, axis=0):
    return tgt.clone().index_add_(axis, idx, src)
def _segment_sum(src, seg, n):
    out = torch.zeros((n,) + src.shape[1:], dtype=src.dtype)
    return out.index_add_(0, seg, src)
def _pad(x, pw):
    flat = tuple(v for pair in reversed(pw) for v in pair)
    return torch.nn.functional.pad(x, flat)

kernel_name = 'recurrent_scan__mha_block_cached__swiglu_ffn__decode'

def setup_inputs():

    _w = (lambda a: (lambda t: t.to(torch.bfloat16) if t.is_floating_point() else t)(torch.as_tensor(a)))
    def _A_setup():
        B, Sq, D = 1, 1, 512
        H, Sk, Dh = 32, 32768, 128
        return {
            "x": _w((lambda *s: torch.randn(*s, dtype=torch.bfloat16) * 0.05)(B, Sq, D)),
            "k_cache": _w((lambda *s: torch.randn(*s, dtype=torch.bfloat16) * 0.8)(B, H, Sk, Dh)),
            "v_cache": _w((lambda *s: torch.randn(*s, dtype=torch.bfloat16) * 0.8)(B, H, Sk, Dh)),
            "wq": _w((lambda *s: torch.randn(*s, dtype=torch.bfloat16) * 0.8)(D, H * Dh) * (D ** -0.5)),
            "wo": _w((lambda *s: torch.randn(*s, dtype=torch.bfloat16) * 0.8)(H * Dh, D) * ((H * Dh) ** -0.5)),
        }
    _A_in = _A_setup()

    def _B_setup():
        B, S, D, F = 1, 1, 512, 1376
        return {
            "x": _w((lambda *s: torch.randn(*s, dtype=torch.bfloat16) * 0.05)(B, S, D)),
            "w_gate": _w((lambda *s: torch.randn(*s, dtype=torch.bfloat16) * 0.2)(D, F)),
            "w_up": _w((lambda *s: torch.randn(*s, dtype=torch.bfloat16) * 0.2)(D, F)),
            "w_down": _w((lambda *s: torch.randn(*s, dtype=torch.bfloat16) * 0.2)(F, D)),
        }
    _B_in = _B_setup()

    return {
        "A_x": _A_in["x"],
        "A_k_cache": _A_in["k_cache"],
        "A_v_cache": _A_in["v_cache"],
        "A_wq": _A_in["wq"],
        "A_wo": _A_in["wo"],
        "B_x": _B_in["x"],
        "B_w_gate": _B_in["w_gate"],
        "B_w_up": _B_in["w_up"],
        "B_w_down": _B_in["w_down"],
    }

def reference(A_x, A_k_cache, A_v_cache, A_wq, A_wo, B_x, B_w_gate, B_w_up, B_w_down):
    def _A_ref(x, k_cache, v_cache, wq, wo):
        B, Sq, D = x.shape
        H, Dh = 32, 128
        q = (lambda x, *d: x.permute(*d))((x @ wq).reshape(B, Sq, H, Dh), 0, 2, 1, 3)
        scores = torch.einsum("bhqd,bhkd->bhqk", q, k_cache) * (Dh ** -0.5)
        p = _softmax(scores, axis=-1)
        o = torch.einsum("bhqk,bhkd->bhqd", p, v_cache)
        return (lambda x, *d: x.permute(*d))(o, 0, 2, 1, 3).reshape(B, Sq, H * Dh) @ wo

    def _B_ref(x, w_gate, w_up, w_down):
        g = _silu(x @ w_gate)
        u = x @ w_up
        return (g * u) @ w_down

    x = A_x
    xn = _layernorm(x, axis=-1)
    s = _A_ref(xn, A_k_cache, A_v_cache, A_wq, A_wo)
    g = _silu(_B_ref(xn, B_w_gate, B_w_up, B_w_down))
    return x + s * g
```

```asm
; @launch grid=(256,1,1) block=(512,1,1) lds=20544
.amdgcn_target "amdgcn-amd-amdhsa--gfx950"
.text
.globl recurrent_scan__mha_block_cached__swiglu_ffn__decode_kernel
.p2align 8
.type recurrent_scan__mha_block_cached__swiglu_ffn__decode_kernel,@function
recurrent_scan__mha_block_cached__swiglu_ffn__decode_kernel:
    s_cmp_ge_u32 s2, 0x100
    s_cbranch_scc1 L_end
    s_load_dwordx16 s[52:67], s[0:1], 0
    s_load_dwordx8 s[68:75], s[0:1], 64
    s_and_b32 s6, s2, 7
    s_lshr_b32 s49, s2, 3
    s_mul_i32 s7, s6, 4
    s_add_u32 s7, s7, s49
    s_and_b32 s7, s7, 31
    s_lshl_b32 s7, s7, 3
    s_or_b32 s2, s7, s6
    s_getpc_b64 s[6:7]
L_pc:
    v_lshlrev_b32 v6, 6, v0
    v_min_u32 v6, L_codeend-L_pc-4, v6
    v_add_co_u32 v6, vcc, s6, v6
    v_mov_b32 v7, s7
    v_addc_co_u32 v7, vcc, 0, v7, vcc
    global_load_dword v255, v[6:7], off
    v_lshrrev_b32 v3, 6, v0
    v_and_b32 v1, 63, v0
    v_readfirstlane_b32 s76, v3
    v_lshlrev_b32 v2, 4, v1
    s_lshr_b32 s77, s2, 3
    s_and_b32 s78, s2, 7
    v_lshrrev_b32 v11, 4, v1
    v_and_b32 v12, 15, v1
    s_mov_b32 s83, 0x3e0293ee
    v_and_b32 v3, 1, v12
    v_lshlrev_b32 v3, 4, v3
    v_mov_b32 v4, 0xffff
    v_lshlrev_b32 v4, v3, v4
    v_lshrrev_b32 v6, 1, v12
    v_cmp_eq_u32_e64 s[94:95], 0, v6
    v_cmp_eq_u32_e64 s[96:97], 1, v6
    v_cmp_eq_u32_e64 s[98:99], 2, v6
    v_cmp_eq_u32_e64 s[100:101], 3, v6
    s_cmp_ge_u32 s76, 4
    v_cndmask_b32_e64 v16, 0, v4, s[94:95]
    v_cndmask_b32_e64 v17, 0, v4, s[96:97]
    v_cndmask_b32_e64 v18, 0, v4, s[98:99]
    v_cndmask_b32_e64 v19, 0, v4, s[100:101]
    s_cbranch_scc0 L_serv
    s_sub_u32 s76, s76, 4
    s_lshl_b32 s89, s77, 23
    s_mul_i32 s84, s77, 3
    s_and_b32 s84, s84, 15
    s_lshl_b32 s84, s84, 19
    s_lshl_b32 s7, s78, 2
    s_add_u32 s7, s7, s76
    s_lshl_b32 s6, s7, 2
    s_mov_b32 s99, s6
    s_mov_b32 s98, s6
    v_mov_b32 v4, -1
    v_mov_b32 v5, -1
    v_mov_b32 v6, -1
    v_mov_b32 v7, -1
    v_mov_b32 v14, 0
    v_mov_b32 v13, 1
    ds_write_b128 v2, v[4:7] offset:3136
    ds_write_b32 v14, v14 offset:3072
    s_mov_b32 s90, 0
    s_mov_b32 s82, 0x40000
    s_mov_b32 s87, 1
    s_lshl_b32 s6, s77, 12
    s_add_u32 s6, s6, 0x180000
    v_mov_b32 v15, s6
    s_mov_b32 s42, 0x200000
    s_mov_b32 s43, 0x20000
    s_bfe_u32 s96, s7, 0x40000
    s_lshl_b32 s96, s96, 12
    s_bfe_u32 s97, s7, 0x10004
    s_lshl_b32 s97, s97, 19
    s_or_b32 s96, s96, s97
    s_bfe_u32 s97, s7, 0x10005
    s_lshl_b32 s97, s97, 18
    s_or_b32 s96, s96, s97
    s_bfe_u32 s97, s7, 0x30006
    s_lshl_b32 s97, s97, 20
    s_or_b32 s96, s96, s97
    s_mov_b32 s7, s96
    s_add_u32 s7, s7, s84
    s_and_b32 s7, s7, 0x7fffff
    s_add_u32 s80, s89, s7
    s_mov_b32 s81, s80
    s_mov_b32 s10, 0x10000000
    s_mov_b32 s11, 0x20000
    s_mov_b32 s14, 0x10000000
    s_mov_b32 s15, 0x20000
    v_lshlrev_b32 v9, 4, v12
    v_and_b32 v3, 1, v11
    v_lshl_add_u32 v9, v3, 8, v9
    v_lshrrev_b32 v3, 1, v11
    v_lshl_add_u32 v9, v3, 9, v9
    v_mov_b32 v38, v9
    s_waitcnt lgkmcnt(0)
    s_load_dword s91, s[74:75], 0xc0000
    s_mov_b32 s8, s54
    s_and_b32 s9, s55, 0xffff
    s_mov_b32 s12, s54
    s_and_b32 s13, s55, 0xffff
    s_mov_b32 s40, s74
    s_and_b32 s41, s75, 0xffff
    s_bfe_u32 s96, s99, 0x60000
    s_lshl_b32 s96, s96, 10
    s_bfe_u32 s97, s99, 0x10006
    s_lshl_b32 s97, s97, 19
    s_or_b32 s96, s96, s97
    s_bfe_u32 s97, s99, 0x10007
    s_lshl_b32 s97, s97, 18
    s_or_b32 s96, s96, s97
    s_bfe_u32 s97, s99, 0x30008
    s_lshl_b32 s97, s97, 20
    s_or_b32 s96, s96, s97
    s_add_u32 s96, s96, s84
    s_and_b32 s96, s96, 0x7fffff
    s_add_u32 s81, s96, s89
    s_add_u32 s99, s99, 1
    buffer_load_dwordx4 v[192:195], v38, s[12:15], s81 offen nt
    s_add_u32 s81, s81, 0x10000
    buffer_load_dwordx4 v[196:199], v38, s[12:15], s81 offen nt
    s_add_u32 s81, s81, 0x10000
    buffer_load_dwordx4 v[200:203], v38, s[12:15], s81 offen nt
    s_add_u32 s81, s81, 0x10000
    buffer_load_dwordx4 v[204:207], v38, s[12:15], s81 offen nt
    s_bfe_u32 s96, s99, 0x60000
    s_lshl_b32 s96, s96, 10
    s_bfe_u32 s97, s99, 0x10006
    s_lshl_b32 s97, s97, 19
    s_or_b32 s96, s96, s97
    s_bfe_u32 s97, s99, 0x10007
    s_lshl_b32 s97, s97, 18
    s_or_b32 s96, s96, s97
    s_bfe_u32 s97, s99, 0x30008
    s_lshl_b32 s97, s97, 20
    s_or_b32 s96, s96, s97
    s_add_u32 s96, s96, s84
    s_and_b32 s96, s96, 0x7fffff
    s_add_u32 s81, s96, s89
    s_add_u32 s99, s99, 1
    buffer_load_dwordx4 v[208:211], v38, s[12:15], s81 offen nt
    s_add_u32 s81, s81, 0x10000
    buffer_load_dwordx4 v[212:215], v38, s[12:15], s81 offen nt
    s_add_u32 s81, s81, 0x10000
    buffer_load_dwordx4 v[216:219], v38, s[12:15], s81 offen nt
    s_add_u32 s81, s81, 0x10000
    buffer_load_dwordx4 v[220:223], v38, s[12:15], s81 offen nt
    s_bfe_u32 s96, s99, 0x60000
    s_lshl_b32 s96, s96, 10
    s_bfe_u32 s97, s99, 0x10006
    s_lshl_b32 s97, s97, 19
    s_or_b32 s96, s96, s97
    s_bfe_u32 s97, s99, 0x10007
    s_lshl_b32 s97, s97, 18
    s_or_b32 s96, s96, s97
    s_bfe_u32 s97, s99, 0x30008
    s_lshl_b32 s97, s97, 20
    s_or_b32 s96, s96, s97
    s_add_u32 s96, s96, s84
    s_and_b32 s96, s96, 0x7fffff
    s_add_u32 s81, s96, s89
    s_add_u32 s99, s99, 1
    buffer_load_dwordx4 v[224:227], v38, s[12:15], s81 offen nt
    s_add_u32 s81, s81, 0x10000
    buffer_load_dwordx4 v[228:231], v38, s[12:15], s81 offen nt
    s_add_u32 s81, s81, 0x10000
    buffer_load_dwordx4 v[232:235], v38, s[12:15], s81 offen nt
    s_add_u32 s81, s81, 0x10000
    buffer_load_dwordx4 v[236:239], v38, s[12:15], s81 offen nt
    s_bfe_u32 s96, s99, 0x60000
    s_lshl_b32 s96, s96, 10
    s_bfe_u32 s97, s99, 0x10006
    s_lshl_b32 s97, s97, 19
    s_or_b32 s96, s96, s97
    s_bfe_u32 s97, s99, 0x10007
    s_lshl_b32 s97, s97, 18
    s_or_b32 s96, s96, s97
    s_bfe_u32 s97, s99, 0x30008
    s_lshl_b32 s97, s97, 20
    s_or_b32 s96, s96, s97
    s_add_u32 s96, s96, s84
    s_and_b32 s96, s96, 0x7fffff
    s_add_u32 s81, s96, s89
    s_add_u32 s99, s99, 125
    buffer_load_dwordx4 v[240:243], v38, s[12:15], s81 offen nt
    s_add_u32 s81, s81, 0x10000
    buffer_load_dwordx4 v[244:247], v38, s[12:15], s81 offen nt
    s_add_u32 s81, s81, 0x10000
    buffer_load_dwordx4 v[248:251], v38, s[12:15], s81 offen nt
    s_add_u32 s81, s81, 0x10000
    buffer_load_dwordx4 v[252:255], v38, s[12:15], s81 offen nt
    s_bfe_u32 s96, s99, 0x60000
    s_lshl_b32 s96, s96, 10
    s_bfe_u32 s97, s99, 0x10006
    s_lshl_b32 s97, s97, 19
    s_or_b32 s96, s96, s97
    s_bfe_u32 s97, s99, 0x10007
    s_lshl_b32 s97, s97, 18
    s_or_b32 s96, s96, s97
    s_bfe_u32 s97, s99, 0x30008
    s_lshl_b32 s97, s97, 20
    s_or_b32 s96, s96, s97
    s_add_u32 s96, s96, s84
    s_and_b32 s96, s96, 0x7fffff
    s_add_u32 s81, s96, s89
    s_add_u32 s99, s99, 1
    buffer_load_dwordx4 v[88:91], v38, s[12:15], s81 offen nt
    s_add_u32 s81, s81, 0x10000
    buffer_load_dwordx4 v[92:95], v38, s[12:15], s81 offen nt
    s_add_u32 s81, s81, 0x10000
    buffer_load_dwordx4 v[96:99], v38, s[12:15], s81 offen nt
    s_add_u32 s81, s81, 0x10000
    buffer_load_dwordx4 v[100:103], v38, s[12:15], s81 offen nt
    s_bfe_u32 s96, s99, 0x60000
    s_lshl_b32 s96, s96, 10
    s_bfe_u32 s97, s99, 0x10006
    s_lshl_b32 s97, s97, 19
    s_or_b32 s96, s96, s97
    s_bfe_u32 s97, s99, 0x10007
    s_lshl_b32 s97, s97, 18
    s_or_b32 s96, s96, s97
    s_bfe_u32 s97, s99, 0x30008
    s_lshl_b32 s97, s97, 20
    s_or_b32 s96, s96, s97
    s_add_u32 s96, s96, s84
    s_and_b32 s96, s96, 0x7fffff
    s_add_u32 s81, s96, s89
    s_add_u32 s99, s99, 1
    buffer_load_dwordx4 v[160:163], v38, s[12:15], s81 offen nt
    s_add_u32 s81, s81, 0x10000
    buffer_load_dwordx4 v[164:167], v38, s[12:15], s81 offen nt
    s_add_u32 s81, s81, 0x10000
    buffer_load_dwordx4 v[168:171], v38, s[12:15], s81 offen nt
    s_add_u32 s81, s81, 0x10000
    buffer_load_dwordx4 v[172:175], v38, s[12:15], s81 offen nt
    s_bfe_u32 s96, s99, 0x60000
    s_lshl_b32 s96, s96, 10
    s_bfe_u32 s97, s99, 0x10006
    s_lshl_b32 s97, s97, 19
    s_or_b32 s96, s96, s97
    s_bfe_u32 s97, s99, 0x10007
    s_lshl_b32 s97, s97, 18
    s_or_b32 s96, s96, s97
    s_bfe_u32 s97, s99, 0x30008
    s_lshl_b32 s97, s97, 20
    s_or_b32 s96, s96, s97
    s_add_u32 s96, s96, s84
    s_and_b32 s96, s96, 0x7fffff
    s_add_u32 s81, s96, s89
    s_add_u32 s99, s99, 1
    buffer_load_dwordx4 v[104:107], v38, s[12:15], s81 offen nt
    s_add_u32 s81, s81, 0x10000
    buffer_load_dwordx4 v[108:111], v38, s[12:15], s81 offen nt
    s_add_u32 s81, s81, 0x10000
    buffer_load_dwordx4 v[112:115], v38, s[12:15], s81 offen nt
    s_add_u32 s81, s81, 0x10000
    buffer_load_dwordx4 v[116:119], v38, s[12:15], s81 offen nt
    s_bfe_u32 s96, s99, 0x60000
    s_lshl_b32 s96, s96, 10
    s_bfe_u32 s97, s99, 0x10006
    s_lshl_b32 s97, s97, 19
    s_or_b32 s96, s96, s97
    s_bfe_u32 s97, s99, 0x10007
    s_lshl_b32 s97, s97, 18
    s_or_b32 s96, s96, s97
    s_bfe_u32 s97, s99, 0x30008
    s_lshl_b32 s97, s97, 20
    s_or_b32 s96, s96, s97
    s_add_u32 s96, s96, s84
    s_and_b32 s96, s96, 0x7fffff
    s_add_u32 s81, s96, s89
    s_add_u32 s99, s99, 125
    buffer_load_dwordx4 v[176:179], v38, s[12:15], s81 offen nt
    s_add_u32 s81, s81, 0x10000
    buffer_load_dwordx4 v[180:183], v38, s[12:15], s81 offen nt
    s_add_u32 s81, s81, 0x10000
    buffer_load_dwordx4 v[184:187], v38, s[12:15], s81 offen nt
    s_add_u32 s81, s81, 0x10000
    buffer_load_dwordx4 v[188:191], v38, s[12:15], s81 offen nt
    s_bfe_u32 s96, s99, 0x60000
    s_lshl_b32 s96, s96, 10
    s_bfe_u32 s97, s99, 0x10006
    s_lshl_b32 s97, s97, 19
    s_or_b32 s96, s96, s97
    s_bfe_u32 s97, s99, 0x10007
    s_lshl_b32 s97, s97, 18
    s_or_b32 s96, s96, s97
    s_bfe_u32 s97, s99, 0x30008
    s_lshl_b32 s97, s97, 20
    s_or_b32 s96, s96, s97
    s_add_u32 s96, s96, s84
    s_and_b32 s96, s96, 0x7fffff
    s_add_u32 s81, s96, s89
    s_add_u32 s99, s99, 1
    buffer_load_dwordx4 v[56:59], v38, s[12:15], s81 offen nt
    s_add_u32 s81, s81, 0x10000
    buffer_load_dwordx4 v[60:63], v38, s[12:15], s81 offen nt
    s_add_u32 s81, s81, 0x10000
    buffer_load_dwordx4 v[64:67], v38, s[12:15], s81 offen nt
    s_add_u32 s81, s81, 0x10000
    buffer_load_dwordx4 v[68:71], v38, s[12:15], s81 offen nt
    s_bfe_u32 s96, s99, 0x60000
    s_lshl_b32 s96, s96, 10
    s_bfe_u32 s97, s99, 0x10006
    s_lshl_b32 s97, s97, 19
    s_or_b32 s96, s96, s97
    s_bfe_u32 s97, s99, 0x10007
    s_lshl_b32 s97, s97, 18
    s_or_b32 s96, s96, s97
    s_bfe_u32 s97, s99, 0x30008
    s_lshl_b32 s97, s97, 20
    s_or_b32 s96, s96, s97
    s_add_u32 s96, s96, s84
    s_and_b32 s96, s96, 0x7fffff
    s_add_u32 s81, s96, s89
    s_add_u32 s99, s99, 1
    buffer_load_dwordx4 v[128:131], v38, s[12:15], s81 offen nt
    s_add_u32 s81, s81, 0x10000
    buffer_load_dwordx4 v[132:135], v38, s[12:15], s81 offen nt
    s_add_u32 s81, s81, 0x10000
    buffer_load_dwordx4 v[136:139], v38, s[12:15], s81 offen nt
    s_add_u32 s81, s81, 0x10000
    buffer_load_dwordx4 v[140:143], v38, s[12:15], s81 offen nt
    s_bfe_u32 s96, s99, 0x60000
    s_lshl_b32 s96, s96, 10
    s_bfe_u32 s97, s99, 0x10006
    s_lshl_b32 s97, s97, 19
    s_or_b32 s96, s96, s97
    s_bfe_u32 s97, s99, 0x10007
    s_lshl_b32 s97, s97, 18
    s_or_b32 s96, s96, s97
    s_bfe_u32 s97, s99, 0x30008
    s_lshl_b32 s97, s97, 20
    s_or_b32 s96, s96, s97
    s_add_u32 s96, s96, s84
    s_and_b32 s96, s96, 0x7fffff
    s_add_u32 s81, s96, s89
    s_add_u32 s99, s99, 1
    buffer_load_dwordx4 v[72:75], v38, s[12:15], s81 offen nt
    s_add_u32 s81, s81, 0x10000
    buffer_load_dwordx4 v[76:79], v38, s[12:15], s81 offen nt
    s_add_u32 s81, s81, 0x10000
    buffer_load_dwordx4 v[80:83], v38, s[12:15], s81 offen nt
    s_add_u32 s81, s81, 0x10000
    buffer_load_dwordx4 v[84:87], v38, s[12:15], s81 offen nt
    s_bfe_u32 s96, s99, 0x60000
    s_lshl_b32 s96, s96, 10
    s_bfe_u32 s97, s99, 0x10006
    s_lshl_b32 s97, s97, 19
    s_or_b32 s96, s96, s97
    s_bfe_u32 s97, s99, 0x10007
    s_lshl_b32 s97, s97, 18
    s_or_b32 s96, s96, s97
    s_bfe_u32 s97, s99, 0x30008
    s_lshl_b32 s97, s97, 20
    s_or_b32 s96, s96, s97
    s_add_u32 s96, s96, s84
    s_and_b32 s96, s96, 0x7fffff
    s_add_u32 s81, s96, s89
    s_add_u32 s99, s99, 125
    buffer_load_dwordx4 v[144:147], v38, s[12:15], s81 offen nt
    s_add_u32 s81, s81, 0x10000
    buffer_load_dwordx4 v[148:151], v38, s[12:15], s81 offen nt
    s_add_u32 s81, s81, 0x10000
    buffer_load_dwordx4 v[152:155], v38, s[12:15], s81 offen nt
    s_add_u32 s81, s81, 0x10000
    buffer_load_dwordx4 v[156:159], v38, s[12:15], s81 offen nt
    v_lshlrev_b32 v3, 4, v12
    s_waitcnt lgkmcnt(0)
    s_add_u32 s91, s91, 1
    s_and_b32 s92, s91, 0xff
    s_barrier
    ds_read_b128 v[20:23], v3 offset:0
    v_mov_b32 v28, 0xff800000
    v_mov_b32 v29, 0
    v_mov_b32 v30, 0
    v_mov_b32 v24, 0
    v_mov_b32 v25, 0
    v_mov_b32 v26, 0
    v_mov_b32 v27, 0
    s_mov_b32 s88, 0
    s_lshl_b32 s6, s76, 12
    s_add_u32 s6, s6, 4160
    v_lshrrev_b32 v3, 2, v1
    v_lshl_add_u32 v41, v3, 2, s6
    v_mov_b32 v40, 0xff800000
    s_mov_b32 s100, 0
    s_waitcnt lgkmcnt(0)
    s_waitcnt vmcnt(44)
    v_dot2_f32_bf16 v32, v192, v20, 0
    v_dot2_f32_bf16 v33, v196, v20, 0
    v_dot2_f32_bf16 v34, v200, v20, 0
    v_dot2_f32_bf16 v35, v204, v20, 0
    v_dot2_f32_bf16 v32, v193, v21, v32
    v_dot2_f32_bf16 v33, v197, v21, v33
    v_dot2_f32_bf16 v34, v201, v21, v34
    v_dot2_f32_bf16 v35, v205, v21, v35
    v_dot2_f32_bf16 v32, v194, v22, v32
    v_dot2_f32_bf16 v33, v198, v22, v33
    v_dot2_f32_bf16 v34, v202, v22, v34
    v_dot2_f32_bf16 v35, v206, v22, v35
    v_dot2_f32_bf16 v32, v195, v23, v32
    v_dot2_f32_bf16 v33, v199, v23, v33
    v_dot2_f32_bf16 v34, v203, v23, v34
    v_dot2_f32_bf16 v35, v207, v23, v35
    s_nop 0
    v_add_f32_dpp v32, v32, v32 row_ror:8 row_mask:0xf bank_mask:0x3
    v_add_f32_dpp v32, v33, v33 row_ror:8 row_mask:0xf bank_mask:0xc
    v_add_f32_dpp v34, v34, v34 row_ror:8 row_mask:0xf bank_mask:0x3
    v_add_f32_dpp v34, v35, v35 row_ror:8 row_mask:0xf bank_mask:0xc
    s_nop 0
    v_add_f32_dpp v33, v32, v32 row_half_mirror row_mask:0xf bank_mask:0x5
    v_add_f32_dpp v33, v34, v34 row_half_mirror row_mask:0xf bank_mask:0xa
    s_nop 1
    v_add_f32_dpp v33, v33, v33 quad_perm:[1,0,3,2] row_mask:0xf bank_mask:0xf
    s_nop 1
    v_add_f32_dpp v33, v33, v33 quad_perm:[2,3,0,1] row_mask:0xf bank_mask:0xf
    s_nop 0
    v_max_f32 v40, v40, v33
    ds_write_b32 v41, v33 offset:0
    s_waitcnt vmcnt(40)
    v_dot2_f32_bf16 v32, v208, v20, 0
    v_dot2_f32_bf16 v33, v212, v20, 0
    v_dot2_f32_bf16 v34, v216, v20, 0
    v_dot2_f32_bf16 v35, v220, v20, 0
    v_dot2_f32_bf16 v32, v209, v21, v32
    v_dot2_f32_bf16 v33, v213, v21, v33
    v_dot2_f32_bf16 v34, v217, v21, v34
    v_dot2_f32_bf16 v35, v221, v21, v35
    v_dot2_f32_bf16 v32, v210, v22, v32
    v_dot2_f32_bf16 v33, v214, v22, v33
    v_dot2_f32_bf16 v34, v218, v22, v34
    v_dot2_f32_bf16 v35, v222, v22, v35
    v_dot2_f32_bf16 v32, v211, v23, v32
    v_dot2_f32_bf16 v33, v215, v23, v33
    v_dot2_f32_bf16 v34, v219, v23, v34
    v_dot2_f32_bf16 v35, v223, v23, v35
    s_nop 0
    v_add_f32_dpp v32, v32, v32 row_ror:8 row_mask:0xf bank_mask:0x3
    v_add_f32_dpp v32, v33, v33 row_ror:8 row_mask:0xf bank_mask:0xc
    v_add_f32_dpp v34, v34, v34 row_ror:8 row_mask:0xf bank_mask:0x3
    v_add_f32_dpp v34, v35, v35 row_ror:8 row_mask:0xf bank_mask:0xc
    s_nop 0
    v_add_f32_dpp v33, v32, v32 row_half_mirror row_mask:0xf bank_mask:0x5
    v_add_f32_dpp v33, v34, v34 row_half_mirror row_mask:0xf bank_mask:0xa
    s_nop 1
    v_add_f32_dpp v33, v33, v33 quad_perm:[1,0,3,2] row_mask:0xf bank_mask:0xf
    s_nop 1
    v_add_f32_dpp v33, v33, v33 quad_perm:[2,3,0,1] row_mask:0xf bank_mask:0xf
    s_nop 0
    v_max_f32 v40, v40, v33
    ds_write_b32 v41, v33 offset:64
    s_waitcnt vmcnt(36)
    v_dot2_f32_bf16 v32, v224, v20, 0
    v_dot2_f32_bf16 v33, v228, v20, 0
    v_dot2_f32_bf16 v34, v232, v20, 0
    v_dot2_f32_bf16 v35, v236, v20, 0
    v_dot2_f32_bf16 v32, v225, v21, v32
    v_dot2_f32_bf16 v33, v229, v21, v33
    v_dot2_f32_bf16 v34, v233, v21, v34
    v_dot2_f32_bf16 v35, v237, v21, v35
    v_dot2_f32_bf16 v32, v226, v22, v32
    v_dot2_f32_bf16 v33, v230, v22, v33
    v_dot2_f32_bf16 v34, v234, v22, v34
    v_dot2_f32_bf16 v35, v238, v22, v35
    v_dot2_f32_bf16 v32, v227, v23, v32
    v_dot2_f32_bf16 v33, v231, v23, v33
    v_dot2_f32_bf16 v34, v235, v23, v34
    v_dot2_f32_bf16 v35, v239, v23, v35
    s_nop 0
    v_add_f32_dpp v32, v32, v32 row_ror:8 row_mask:0xf bank_mask:0x3
    v_add_f32_dpp v32, v33, v33 row_ror:8 row_mask:0xf bank_mask:0xc
    v_add_f32_dpp v34, v34, v34 row_ror:8 row_mask:0xf bank_mask:0x3
    v_add_f32_dpp v34, v35, v35 row_ror:8 row_mask:0xf bank_mask:0xc
    s_nop 0
    v_add_f32_dpp v33, v32, v32 row_half_mirror row_mask:0xf bank_mask:0x5
    v_add_f32_dpp v33, v34, v34 row_half_mirror row_mask:0xf bank_mask:0xa
    s_nop 1
    v_add_f32_dpp v33, v33, v33 quad_perm:[1,0,3,2] row_mask:0xf bank_mask:0xf
    s_nop 1
    v_add_f32_dpp v33, v33, v33 quad_perm:[2,3,0,1] row_mask:0xf bank_mask:0xf
    s_nop 0
    v_max_f32 v40, v40, v33
    ds_write_b32 v41, v33 offset:128
    s_waitcnt vmcnt(32)
    v_dot2_f32_bf16 v32, v240, v20, 0
    v_dot2_f32_bf16 v33, v244, v20, 0
    v_dot2_f32_bf16 v34, v248, v20, 0
    v_dot2_f32_bf16 v35, v252, v20, 0
    v_dot2_f32_bf16 v32, v241, v21, v32
    v_dot2_f32_bf16 v33, v245, v21, v33
    v_dot2_f32_bf16 v34, v249, v21, v34
    v_dot2_f32_bf16 v35, v253, v21, v35
    v_dot2_f32_bf16 v32, v242, v22, v32
    v_dot2_f32_bf16 v33, v246, v22, v33
    v_dot2_f32_bf16 v34, v250, v22, v34
    v_dot2_f32_bf16 v35, v254, v22, v35
    v_dot2_f32_bf16 v32, v243, v23, v32
    v_dot2_f32_bf16 v33, v247, v23, v33
    v_dot2_f32_bf16 v34, v251, v23, v34
    v_dot2_f32_bf16 v35, v255, v23, v35
    s_nop 0
    v_add_f32_dpp v32, v32, v32 row_ror:8 row_mask:0xf bank_mask:0x3
    v_add_f32_dpp v32, v33, v33 row_ror:8 row_mask:0xf bank_mask:0xc
    v_add_f32_dpp v34, v34, v34 row_ror:8 row_mask:0xf bank_mask:0x3
    v_add_f32_dpp v34, v35, v35 row_ror:8 row_mask:0xf bank_mask:0xc
    s_nop 0
    v_add_f32_dpp v33, v32, v32 row_half_mirror row_mask:0xf bank_mask:0x5
    v_add_f32_dpp v33, v34, v34 row_half_mirror row_mask:0xf bank_mask:0xa
    s_nop 1
    v_add_f32_dpp v33, v33, v33 quad_perm:[1,0,3,2] row_mask:0xf bank_mask:0xf
    s_nop 1
    v_add_f32_dpp v33, v33, v33 quad_perm:[2,3,0,1] row_mask:0xf bank_mask:0xf
    s_nop 0
    v_max_f32 v40, v40, v33
    ds_write_b32 v41, v33 offset:192
    v_add_u32 v41, 256, v41
    s_mov_b32 s100, 3
    s_bfe_u32 s96, s99, 0x60000
    s_lshl_b32 s96, s96, 10
    s_bfe_u32 s97, s99, 0x10006
    s_lshl_b32 s97, s97, 19
    s_or_b32 s96, s96, s97
    s_bfe_u32 s97, s99, 0x10007
    s_lshl_b32 s97, s97, 18
    s_or_b32 s96, s96, s97
    s_bfe_u32 s97, s99, 0x30008
    s_lshl_b32 s97, s97, 20
    s_or_b32 s96, s96, s97
    s_add_u32 s96, s96, s84
    s_and_b32 s96, s96, 0x7fffff
    s_add_u32 s81, s96, s89
    s_add_u32 s99, s99, 1
    s_waitcnt vmcnt(28)
    v_dot2_f32_bf16 v32, v88, v20, 0
    v_dot2_f32_bf16 v33, v92, v20, 0
    v_dot2_f32_bf16 v34, v96, v20, 0
    v_dot2_f32_bf16 v35, v100, v20, 0
    v_dot2_f32_bf16 v32, v89, v21, v32
    v_dot2_f32_bf16 v33, v93, v21, v33
    v_dot2_f32_bf16 v34, v97, v21, v34
    v_dot2_f32_bf16 v35, v101, v21, v35
    v_dot2_f32_bf16 v32, v90, v22, v32
    v_dot2_f32_bf16 v33, v94, v22, v33
    v_dot2_f32_bf16 v34, v98, v22, v34
    v_dot2_f32_bf16 v35, v102, v22, v35
    v_dot2_f32_bf16 v32, v91, v23, v32
    v_dot2_f32_bf16 v33, v95, v23, v33
    v_dot2_f32_bf16 v34, v99, v23, v34
    v_dot2_f32_bf16 v35, v103, v23, v35
    buffer_load_dwordx4 v[88:91], v38, s[12:15], s81 offen nt
    s_add_u32 s81, s81, 0x10000
    buffer_load_dwordx4 v[92:95], v38, s[12:15], s81 offen nt
    s_add_u32 s81, s81, 0x10000
    buffer_load_dwordx4 v[96:99], v38, s[12:15], s81 offen nt
    s_add_u32 s81, s81, 0x10000
    v_add_f32_dpp v32, v32, v32 row_ror:8 row_mask:0xf bank_mask:0x3
    v_add_f32_dpp v32, v33, v33 row_ror:8 row_mask:0xf bank_mask:0xc
    v_add_f32_dpp v34, v34, v34 row_ror:8 row_mask:0xf bank_mask:0x3
    v_add_f32_dpp v34, v35, v35 row_ror:8 row_mask:0xf bank_mask:0xc
    buffer_load_dwordx4 v[100:103], v38, s[12:15], s81 offen nt
    v_add_f32_dpp v33, v32, v32 row_half_mirror row_mask:0xf bank_mask:0x5
    v_add_f32_dpp v33, v34, v34 row_half_mirror row_mask:0xf bank_mask:0xa
    s_nop 1
    v_add_f32_dpp v33, v33, v33 quad_perm:[1,0,3,2] row_mask:0xf bank_mask:0xf
    s_nop 1
    v_add_f32_dpp v33, v33, v33 quad_perm:[2,3,0,1] row_mask:0xf bank_mask:0xf
    s_nop 0
    v_max_f32 v40, v40, v33
    ds_write_b32 v41, v33 offset:0
    s_bfe_u32 s96, s99, 0x60000
    s_lshl_b32 s96, s96, 10
    s_bfe_u32 s97, s99, 0x10006
    s_lshl_b32 s97, s97, 19
    s_or_b32 s96, s96, s97
    s_bfe_u32 s97, s99, 0x10007
    s_lshl_b32 s97, s97, 18
    s_or_b32 s96, s96, s97
    s_bfe_u32 s97, s99, 0x30008
    s_lshl_b32 s97, s97, 20
    s_or_b32 s96, s96, s97
    s_add_u32 s96, s96, s84
    s_and_b32 s96, s96, 0x7fffff
    s_add_u32 s81, s96, s89
    s_add_u32 s99, s99, 1
    s_waitcnt vmcnt(28)
    v_dot2_f32_bf16 v32, v160, v20, 0
    v_dot2_f32_bf16 v33, v164, v20, 0
    v_dot2_f32_bf16 v34, v168, v20, 0
    v_dot2_f32_bf16 v35, v172, v20, 0
    v_dot2_f32_bf16 v32, v161, v21, v32
    v_dot2_f32_bf16 v33, v165, v21, v33
    v_dot2_f32_bf16 v34, v169, v21, v34
    v_dot2_f32_bf16 v35, v173, v21, v35
    v_dot2_f32_bf16 v32, v162, v22, v32
    v_dot2_f32_bf16 v33, v166, v22, v33
    v_dot2_f32_bf16 v34, v170, v22, v34
    v_dot2_f32_bf16 v35, v174, v22, v35
    v_dot2_f32_bf16 v32, v163, v23, v32
    v_dot2_f32_bf16 v33, v167, v23, v33
    v_dot2_f32_bf16 v34, v171, v23, v34
    v_dot2_f32_bf16 v35, v175, v23, v35
    buffer_load_dwordx4 v[160:163], v38, s[12:15], s81 offen nt
    s_add_u32 s81, s81, 0x10000
    buffer_load_dwordx4 v[164:167], v38, s[12:15], s81 offen nt
    s_add_u32 s81, s81, 0x10000
    buffer_load_dwordx4 v[168:171], v38, s[12:15], s81 offen nt
    s_add_u32 s81, s81, 0x10000
    v_add_f32_dpp v32, v32, v32 row_ror:8 row_mask:0xf bank_mask:0x3
    v_add_f32_dpp v32, v33, v33 row_ror:8 row_mask:0xf bank_mask:0xc
    v_add_f32_dpp v34, v34, v34 row_ror:8 row_mask:0xf bank_mask:0x3
    v_add_f32_dpp v34, v35, v35 row_ror:8 row_mask:0xf bank_mask:0xc
    buffer_load_dwordx4 v[172:175], v38, s[12:15], s81 offen nt
    v_add_f32_dpp v33, v32, v32 row_half_mirror row_mask:0xf bank_mask:0x5
    v_add_f32_dpp v33, v34, v34 row_half_mirror row_mask:0xf bank_mask:0xa
    s_nop 1
    v_add_f32_dpp v33, v33, v33 quad_perm:[1,0,3,2] row_mask:0xf bank_mask:0xf
    s_nop 1
    v_add_f32_dpp v33, v33, v33 quad_perm:[2,3,0,1] row_mask:0xf bank_mask:0xf
    s_nop 0
    v_max_f32 v40, v40, v33
    ds_write_b32 v41, v33 offset:64
    s_bfe_u32 s96, s99, 0x60000
    s_lshl_b32 s96, s96, 10
    s_bfe_u32 s97, s99, 0x10006
    s_lshl_b32 s97, s97, 19
    s_or_b32 s96, s96, s97
    s_bfe_u32 s97, s99, 0x10007
    s_lshl_b32 s97, s97, 18
    s_or_b32 s96, s96, s97
    s_bfe_u32 s97, s99, 0x30008
    s_lshl_b32 s97, s97, 20
    s_or_b32 s96, s96, s97
    s_add_u32 s96, s96, s84
    s_and_b32 s96, s96, 0x7fffff
    s_add_u32 s81, s96, s89
    s_add_u32 s99, s99, 1
    s_waitcnt vmcnt(28)
    v_dot2_f32_bf16 v32, v104, v20, 0
    v_dot2_f32_bf16 v33, v108, v20, 0
    v_dot2_f32_bf16 v34, v112, v20, 0
    v_dot2_f32_bf16 v35, v116, v20, 0
    v_dot2_f32_bf16 v32, v105, v21, v32
    v_dot2_f32_bf16 v33, v109, v21, v33
    v_dot2_f32_bf16 v34, v113, v21, v34
    v_dot2_f32_bf16 v35, v117, v21, v35
    v_dot2_f32_bf16 v32, v106, v22, v32
    v_dot2_f32_bf16 v33, v110, v22, v33
    v_dot2_f32_bf16 v34, v114, v22, v34
    v_dot2_f32_bf16 v35, v118, v22, v35
    v_dot2_f32_bf16 v32, v107, v23, v32
    v_dot2_f32_bf16 v33, v111, v23, v33
    v_dot2_f32_bf16 v34, v115, v23, v34
    v_dot2_f32_bf16 v35, v119, v23, v35
    buffer_load_dwordx4 v[104:107], v38, s[12:15], s81 offen nt
    s_add_u32 s81, s81, 0x10000
    buffer_load_dwordx4 v[108:111], v38, s[12:15], s81 offen nt
    s_add_u32 s81, s81, 0x10000
    buffer_load_dwordx4 v[112:115], v38, s[12:15], s81 offen nt
    s_add_u32 s81, s81, 0x10000
    v_add_f32_dpp v32, v32, v32 row_ror:8 row_mask:0xf bank_mask:0x3
    v_add_f32_dpp v32, v33, v33 row_ror:8 row_mask:0xf bank_mask:0xc
    v_add_f32_dpp v34, v34, v34 row_ror:8 row_mask:0xf bank_mask:0x3
    v_add_f32_dpp v34, v35, v35 row_ror:8 row_mask:0xf bank_mask:0xc
    buffer_load_dwordx4 v[116:119], v38, s[12:15], s81 offen nt
    v_add_f32_dpp v33, v32, v32 row_half_mirror row_mask:0xf bank_mask:0x5
    v_add_f32_dpp v33, v34, v34 row_half_mirror row_mask:0xf bank_mask:0xa
    s_nop 1
    v_add_f32_dpp v33, v33, v33 quad_perm:[1,0,3,2] row_mask:0xf bank_mask:0xf
    s_nop 1
    v_add_f32_dpp v33, v33, v33 quad_perm:[2,3,0,1] row_mask:0xf bank_mask:0xf
    s_nop 0
    v_max_f32 v40, v40, v33
    ds_write_b32 v41, v33 offset:128
    s_bfe_u32 s96, s99, 0x60000
    s_lshl_b32 s96, s96, 10
    s_bfe_u32 s97, s99, 0x10006
    s_lshl_b32 s97, s97, 19
    s_or_b32 s96, s96, s97
    s_bfe_u32 s97, s99, 0x10007
    s_lshl_b32 s97, s97, 18
    s_or_b32 s96, s96, s97
    s_bfe_u32 s97, s99, 0x30008
    s_lshl_b32 s97, s97, 20
    s_or_b32 s96, s96, s97
    s_add_u32 s96, s96, s84
    s_and_b32 s96, s96, 0x7fffff
    s_add_u32 s81, s96, s89
    s_add_u32 s99, s99, 125
    s_waitcnt vmcnt(28)
    v_dot2_f32_bf16 v32, v176, v20, 0
    v_dot2_f32_bf16 v33, v180, v20, 0
    v_dot2_f32_bf16 v34, v184, v20, 0
    v_dot2_f32_bf16 v35, v188, v20, 0
    v_dot2_f32_bf16 v32, v177, v21, v32
    v_dot2_f32_bf16 v33, v181, v21, v33
    v_dot2_f32_bf16 v34, v185, v21, v34
    v_dot2_f32_bf16 v35, v189, v21, v35
    v_dot2_f32_bf16 v32, v178, v22, v32
    v_dot2_f32_bf16 v33, v182, v22, v33
    v_dot2_f32_bf16 v34, v186, v22, v34
    v_dot2_f32_bf16 v35, v190, v22, v35
    v_dot2_f32_bf16 v32, v179, v23, v32
    v_dot2_f32_bf16 v33, v183, v23, v33
    v_dot2_f32_bf16 v34, v187, v23, v34
    v_dot2_f32_bf16 v35, v191, v23, v35
    buffer_load_dwordx4 v[176:179], v38, s[12:15], s81 offen nt
    s_add_u32 s81, s81, 0x10000
    buffer_load_dwordx4 v[180:183], v38, s[12:15], s81 offen nt
    s_add_u32 s81, s81, 0x10000
    buffer_load_dwordx4 v[184:187], v38, s[12:15], s81 offen nt
    s_add_u32 s81, s81, 0x10000
    v_add_f32_dpp v32, v32, v32 row_ror:8 row_mask:0xf bank_mask:0x3
    v_add_f32_dpp v32, v33, v33 row_ror:8 row_mask:0xf bank_mask:0xc
    v_add_f32_dpp v34, v34, v34 row_ror:8 row_mask:0xf bank_mask:0x3
    v_add_f32_dpp v34, v35, v35 row_ror:8 row_mask:0xf bank_mask:0xc
    buffer_load_dwordx4 v[188:191], v38, s[12:15], s81 offen nt
    v_add_f32_dpp v33, v32, v32 row_half_mirror row_mask:0xf bank_mask:0x5
    v_add_f32_dpp v33, v34, v34 row_half_mirror row_mask:0xf bank_mask:0xa
    s_nop 1
    v_add_f32_dpp v33, v33, v33 quad_perm:[1,0,3,2] row_mask:0xf bank_mask:0xf
    s_nop 1
    v_add_f32_dpp v33, v33, v33 quad_perm:[2,3,0,1] row_mask:0xf bank_mask:0xf
    s_nop 0
    v_max_f32 v40, v40, v33
    ds_write_b32 v41, v33 offset:192
    v_add_u32 v41, 256, v41
    s_bfe_u32 s96, s99, 0x60000
    s_lshl_b32 s96, s96, 10
    s_bfe_u32 s97, s99, 0x10006
    s_lshl_b32 s97, s97, 19
    s_or_b32 s96, s96, s97
    s_bfe_u32 s97, s99, 0x10007
    s_lshl_b32 s97, s97, 18
    s_or_b32 s96, s96, s97
    s_bfe_u32 s97, s99, 0x30008
    s_lshl_b32 s97, s97, 20
    s_or_b32 s96, s96, s97
    s_add_u32 s96, s96, s84
    s_and_b32 s96, s96, 0x7fffff
    s_add_u32 s81, s96, s89
    s_add_u32 s99, s99, 1
    s_waitcnt vmcnt(28)
    v_dot2_f32_bf16 v32, v56, v20, 0
    v_dot2_f32_bf16 v33, v60, v20, 0
    v_dot2_f32_bf16 v34, v64, v20, 0
    v_dot2_f32_bf16 v35, v68, v20, 0
    v_dot2_f32_bf16 v32, v57, v21, v32
    v_dot2_f32_bf16 v33, v61, v21, v33
    v_dot2_f32_bf16 v34, v65, v21, v34
    v_dot2_f32_bf16 v35, v69, v21, v35
    v_dot2_f32_bf16 v32, v58, v22, v32
    v_dot2_f32_bf16 v33, v62, v22, v33
    v_dot2_f32_bf16 v34, v66, v22, v34
    v_dot2_f32_bf16 v35, v70, v22, v35
    v_dot2_f32_bf16 v32, v59, v23, v32
    v_dot2_f32_bf16 v33, v63, v23, v33
    v_dot2_f32_bf16 v34, v67, v23, v34
    v_dot2_f32_bf16 v35, v71, v23, v35
    buffer_load_dwordx4 v[56:59], v38, s[12:15], s81 offen nt
    s_add_u32 s81, s81, 0x10000
    buffer_load_dwordx4 v[60:63], v38, s[12:15], s81 offen nt
    s_add_u32 s81, s81, 0x10000
    buffer_load_dwordx4 v[64:67], v38, s[12:15], s81 offen nt
    s_add_u32 s81, s81, 0x10000
    v_add_f32_dpp v32, v32, v32 row_ror:8 row_mask:0xf bank_mask:0x3
    v_add_f32_dpp v32, v33, v33 row_ror:8 row_mask:0xf bank_mask:0xc
    v_add_f32_dpp v34, v34, v34 row_ror:8 row_mask:0xf bank_mask:0x3
    v_add_f32_dpp v34, v35, v35 row_ror:8 row_mask:0xf bank_mask:0xc
    buffer_load_dwordx4 v[68:71], v38, s[12:15], s81 offen nt
    v_add_f32_dpp v33, v32, v32 row_half_mirror row_mask:0xf bank_mask:0x5
    v_add_f32_dpp v33, v34, v34 row_half_mirror row_mask:0xf bank_mask:0xa
    s_nop 1
    v_add_f32_dpp v33, v33, v33 quad_perm:[1,0,3,2] row_mask:0xf bank_mask:0xf
    s_nop 1
    v_add_f32_dpp v33, v33, v33 quad_perm:[2,3,0,1] row_mask:0xf bank_mask:0xf
    s_nop 0
    v_max_f32 v40, v40, v33
    ds_write_b32 v41, v33 offset:0
    s_bfe_u32 s96, s99, 0x60000
    s_lshl_b32 s96, s96, 10
    s_bfe_u32 s97, s99, 0x10006
    s_lshl_b32 s97, s97, 19
    s_or_b32 s96, s96, s97
    s_bfe_u32 s97, s99, 0x10007
    s_lshl_b32 s97, s97, 18
    s_or_b32 s96, s96, s97
    s_bfe_u32 s97, s99, 0x30008
    s_lshl_b32 s97, s97, 20
    s_or_b32 s96, s96, s97
    s_add_u32 s96, s96, s84
    s_and_b32 s96, s96, 0x7fffff
    s_add_u32 s81, s96, s89
    s_add_u32 s99, s99, 1
    s_waitcnt vmcnt(28)
    v_dot2_f32_bf16 v32, v128, v20, 0
    v_dot2_f32_bf16 v33, v132, v20, 0
    v_dot2_f32_bf16 v34, v136, v20, 0
    v_dot2_f32_bf16 v35, v140, v20, 0
    v_dot2_f32_bf16 v32, v129, v21, v32
    v_dot2_f32_bf16 v33, v133, v21, v33
    v_dot2_f32_bf16 v34, v137, v21, v34
    v_dot2_f32_bf16 v35, v141, v21, v35
    v_dot2_f32_bf16 v32, v130, v22, v32
    v_dot2_f32_bf16 v33, v134, v22, v33
    v_dot2_f32_bf16 v34, v138, v22, v34
    v_dot2_f32_bf16 v35, v142, v22, v35
    v_dot2_f32_bf16 v32, v131, v23, v32
    v_dot2_f32_bf16 v33, v135, v23, v33
    v_dot2_f32_bf16 v34, v139, v23, v34
    v_dot2_f32_bf16 v35, v143, v23, v35
    buffer_load_dwordx4 v[128:131], v38, s[12:15], s81 offen nt
    s_add_u32 s81, s81, 0x10000
    buffer_load_dwordx4 v[132:135], v38, s[12:15], s81 offen nt
    s_add_u32 s81, s81, 0x10000
    buffer_load_dwordx4 v[136:139], v38, s[12:15], s81 offen nt
    s_add_u32 s81, s81, 0x10000
    v_add_f32_dpp v32, v32, v32 row_ror:8 row_mask:0xf bank_mask:0x3
    v_add_f32_dpp v32, v33, v33 row_ror:8 row_mask:0xf bank_mask:0xc
    v_add_f32_dpp v34, v34, v34 row_ror:8 row_mask:0xf bank_mask:0x3
    v_add_f32_dpp v34, v35, v35 row_ror:8 row_mask:0xf bank_mask:0xc
    buffer_load_dwordx4 v[140:143], v38, s[12:15], s81 offen nt
    v_add_f32_dpp v33, v32, v32 row_half_mirror row_mask:0xf bank_mask:0x5
    v_add_f32_dpp v33, v34, v34 row_half_mirror row_mask:0xf bank_mask:0xa
    s_nop 1
    v_add_f32_dpp v33, v33, v33 quad_perm:[1,0,3,2] row_mask:0xf bank_mask:0xf
    s_nop 1
    v_add_f32_dpp v33, v33, v33 quad_perm:[2,3,0,1] row_mask:0xf bank_mask:0xf
    s_nop 0
    v_max_f32 v40, v40, v33
    ds_write_b32 v41, v33 offset:64
    s_bfe_u32 s96, s99, 0x60000
    s_lshl_b32 s96, s96, 10
    s_bfe_u32 s97, s99, 0x10006
    s_lshl_b32 s97, s97, 19
    s_or_b32 s96, s96, s97
    s_bfe_u32 s97, s99, 0x10007
    s_lshl_b32 s97, s97, 18
    s_or_b32 s96, s96, s97
    s_bfe_u32 s97, s99, 0x30008
    s_lshl_b32 s97, s97, 20
    s_or_b32 s96, s96, s97
    s_add_u32 s96, s96, s84
    s_and_b32 s96, s96, 0x7fffff
    s_add_u32 s81, s96, s89
    s_add_u32 s99, s99, 1
    s_waitcnt vmcnt(28)
    v_dot2_f32_bf16 v32, v72, v20, 0
    v_dot2_f32_bf16 v33, v76, v20, 0
    v_dot2_f32_bf16 v34, v80, v20, 0
    v_dot2_f32_bf16 v35, v84, v20, 0
    v_dot2_f32_bf16 v32, v73, v21, v32
    v_dot2_f32_bf16 v33, v77, v21, v33
    v_dot2_f32_bf16 v34, v81, v21, v34
    v_dot2_f32_bf16 v35, v85, v21, v35
    v_dot2_f32_bf16 v32, v74, v22, v32
    v_dot2_f32_bf16 v33, v78, v22, v33
    v_dot2_f32_bf16 v34, v82, v22, v34
    v_dot2_f32_bf16 v35, v86, v22, v35
    v_dot2_f32_bf16 v32, v75, v23, v32
    v_dot2_f32_bf16 v33, v79, v23, v33
    v_dot2_f32_bf16 v34, v83, v23, v34
    v_dot2_f32_bf16 v35, v87, v23, v35
    buffer_load_dwordx4 v[72:75], v38, s[12:15], s81 offen nt
    s_add_u32 s81, s81, 0x10000
    buffer_load_dwordx4 v[76:79], v38, s[12:15], s81 offen nt
    s_add_u32 s81, s81, 0x10000
    buffer_load_dwordx4 v[80:83], v38, s[12:15], s81 offen nt
    s_add_u32 s81, s81, 0x10000
    v_add_f32_dpp v32, v32, v32 row_ror:8 row_mask:0xf bank_mask:0x3
    v_add_f32_dpp v32, v33, v33 row_ror:8 row_mask:0xf bank_mask:0xc
    v_add_f32_dpp v34, v34, v34 row_ror:8 row_mask:0xf bank_mask:0x3
    v_add_f32_dpp v34, v35, v35 row_ror:8 row_mask:0xf bank_mask:0xc
    buffer_load_dwordx4 v[84:87], v38, s[12:15], s81 offen nt
    v_add_f32_dpp v33, v32, v32 row_half_mirror row_mask:0xf bank_mask:0x5
    v_add_f32_dpp v33, v34, v34 row_half_mirror row_mask:0xf bank_mask:0xa
    s_nop 1
    v_add_f32_dpp v33, v33, v33 quad_perm:[1,0,3,2] row_mask:0xf bank_mask:0xf
    s_nop 1
    v_add_f32_dpp v33, v33, v33 quad_perm:[2,3,0,1] row_mask:0xf bank_mask:0xf
    s_nop 0
    v_max_f32 v40, v40, v33
    ds_write_b32 v41, v33 offset:128
    s_bfe_u32 s96, s99, 0x60000
    s_lshl_b32 s96, s96, 10
    s_bfe_u32 s97, s99, 0x10006
    s_lshl_b32 s97, s97, 19
    s_or_b32 s96, s96, s97
    s_bfe_u32 s97, s99, 0x10007
    s_lshl_b32 s97, s97, 18
    s_or_b32 s96, s96, s97
    s_bfe_u32 s97, s99, 0x30008
    s_lshl_b32 s97, s97, 20
    s_or_b32 s96, s96, s97
    s_add_u32 s96, s96, s84
    s_and_b32 s96, s96, 0x7fffff
    s_add_u32 s81, s96, s89
    s_add_u32 s99, s99, 125
    s_waitcnt vmcnt(28)
    v_dot2_f32_bf16 v32, v144, v20, 0
    v_dot2_f32_bf16 v33, v148, v20, 0
    v_dot2_f32_bf16 v34, v152, v20, 0
    v_dot2_f32_bf16 v35, v156, v20, 0
    v_dot2_f32_bf16 v32, v145, v21, v32
    v_dot2_f32_bf16 v33, v149, v21, v33
    v_dot2_f32_bf16 v34, v153, v21, v34
    v_dot2_f32_bf16 v35, v157, v21, v35
    v_dot2_f32_bf16 v32, v146, v22, v32
    v_dot2_f32_bf16 v33, v150, v22, v33
    v_dot2_f32_bf16 v34, v154, v22, v34
    v_dot2_f32_bf16 v35, v158, v22, v35
    v_dot2_f32_bf16 v32, v147, v23, v32
    v_dot2_f32_bf16 v33, v151, v23, v33
    v_dot2_f32_bf16 v34, v155, v23, v34
    v_dot2_f32_bf16 v35, v159, v23, v35
    buffer_load_dwordx4 v[144:147], v38, s[12:15], s81 offen nt
    s_add_u32 s81, s81, 0x10000
    buffer_load_dwordx4 v[148:151], v38, s[12:15], s81 offen nt
    s_add_u32 s81, s81, 0x10000
    buffer_load_dwordx4 v[152:155], v38, s[12:15], s81 offen nt
    s_add_u32 s81, s81, 0x10000
    v_add_f32_dpp v32, v32, v32 row_ror:8 row_mask:0xf bank_mask:0x3
    v_add_f32_dpp v32, v33, v33 row_ror:8 row_mask:0xf bank_mask:0xc
    v_add_f32_dpp v34, v34, v34 row_ror:8 row_mask:0xf bank_mask:0x3
    v_add_f32_dpp v34, v35, v35 row_ror:8 row_mask:0xf bank_mask:0xc
    buffer_load_dwordx4 v[156:159], v38, s[12:15], s81 offen nt
    v_add_f32_dpp v33, v32, v32 row_half_mirror row_mask:0xf bank_mask:0x5
    v_add_f32_dpp v33, v34, v34 row_half_mirror row_mask:0xf bank_mask:0xa
    s_nop 1
    v_add_f32_dpp v33, v33, v33 quad_perm:[1,0,3,2] row_mask:0xf bank_mask:0xf
    s_nop 1
    v_add_f32_dpp v33, v33, v33 quad_perm:[2,3,0,1] row_mask:0xf bank_mask:0xf
    s_nop 0
    v_max_f32 v40, v40, v33
    ds_write_b32 v41, v33 offset:192
    v_add_u32 v41, 256, v41
    s_branch L_k1
L_k0:
    s_cmp_eq_u32 s100, 11
    s_cbranch_scc0 L_ksw0
    s_mov_b32 s12, s56
    s_and_b32 s13, s57, 0xffff
    s_mov_b32 s99, s98
L_ksw0:
    s_bfe_u32 s96, s99, 0x60000
    s_lshl_b32 s96, s96, 10
    s_bfe_u32 s97, s99, 0x10006
    s_lshl_b32 s97, s97, 19
    s_or_b32 s96, s96, s97
    s_bfe_u32 s97, s99, 0x10007
    s_lshl_b32 s97, s97, 18
    s_or_b32 s96, s96, s97
    s_bfe_u32 s97, s99, 0x30008
    s_lshl_b32 s97, s97, 20
    s_or_b32 s96, s96, s97
    s_add_u32 s96, s96, s84
    s_and_b32 s96, s96, 0x7fffff
    s_add_u32 s81, s96, s89
    s_add_u32 s99, s99, 1
    s_waitcnt vmcnt(6)
    v_dot2_f32_bf16 v32, v56, v20, 0
    v_dot2_f32_bf16 v33, v60, v20, 0
    v_dot2_f32_bf16 v34, v64, v20, 0
    v_dot2_f32_bf16 v35, v68, v20, 0
    v_dot2_f32_bf16 v32, v57, v21, v32
    v_dot2_f32_bf16 v33, v61, v21, v33
    v_dot2_f32_bf16 v34, v65, v21, v34
    v_dot2_f32_bf16 v35, v69, v21, v35
    v_dot2_f32_bf16 v32, v58, v22, v32
    v_dot2_f32_bf16 v33, v62, v22, v33
    v_dot2_f32_bf16 v34, v66, v22, v34
    v_dot2_f32_bf16 v35, v70, v22, v35
    v_dot2_f32_bf16 v32, v59, v23, v32
    v_dot2_f32_bf16 v33, v63, v23, v33
    v_dot2_f32_bf16 v34, v67, v23, v34
    v_dot2_f32_bf16 v35, v71, v23, v35
    buffer_load_dwordx4 v[56:59], v38, s[12:15], s81 offen nt
    s_add_u32 s81, s81, 0x10000
    buffer_load_dwordx4 v[60:63], v38, s[12:15], s81 offen nt
    s_add_u32 s81, s81, 0x10000
    buffer_load_dwordx4 v[64:67], v38, s[12:15], s81 offen nt
    s_add_u32 s81, s81, 0x10000
    v_add_f32_dpp v32, v32, v32 row_ror:8 row_mask:0xf bank_mask:0x3
    v_add_f32_dpp v32, v33, v33 row_ror:8 row_mask:0xf bank_mask:0xc
    v_add_f32_dpp v34, v34, v34 row_ror:8 row_mask:0xf bank_mask:0x3
    v_add_f32_dpp v34, v35, v35 row_ror:8 row_mask:0xf bank_mask:0xc
    buffer_load_dwordx4 v[68:71], v38, s[12:15], s81 offen nt
    v_add_f32_dpp v33, v32, v32 row_half_mirror row_mask:0xf bank_mask:0x5
    v_add_f32_dpp v33, v34, v34 row_half_mirror row_mask:0xf bank_mask:0xa
    s_nop 1
    v_add_f32_dpp v33, v33, v33 quad_perm:[1,0,3,2] row_mask:0xf bank_mask:0xf
    s_nop 1
    v_add_f32_dpp v33, v33, v33 quad_perm:[2,3,0,1] row_mask:0xf bank_mask:0xf
    s_nop 0
    v_max_f32 v40, v40, v33
    ds_write_b32 v41, v33 offset:0
    s_bfe_u32 s96, s99, 0x60000
    s_lshl_b32 s96, s96, 10
    s_bfe_u32 s97, s99, 0x10006
    s_lshl_b32 s97, s97, 19
    s_or_b32 s96, s96, s97
    s_bfe_u32 s97, s99, 0x10007
    s_lshl_b32 s97, s97, 18
    s_or_b32 s96, s96, s97
    s_bfe_u32 s97, s99, 0x30008
    s_lshl_b32 s97, s97, 20
    s_or_b32 s96, s96, s97
    s_add_u32 s96, s96, s84
    s_and_b32 s96, s96, 0x7fffff
    s_add_u32 s81, s96, s89
    s_add_u32 s99, s99, 1
    s_waitcnt vmcnt(6)
    v_dot2_f32_bf16 v32, v128, v20, 0
    v_dot2_f32_bf16 v33, v132, v20, 0
    v_dot2_f32_bf16 v34, v136, v20, 0
    v_dot2_f32_bf16 v35, v140, v20, 0
    v_dot2_f32_bf16 v32, v129, v21, v32
    v_dot2_f32_bf16 v33, v133, v21, v33
    v_dot2_f32_bf16 v34, v137, v21, v34
    v_dot2_f32_bf16 v35, v141, v21, v35
    v_dot2_f32_bf16 v32, v130, v22, v32
    v_dot2_f32_bf16 v33, v134, v22, v33
    v_dot2_f32_bf16 v34, v138, v22, v34
    v_dot2_f32_bf16 v35, v142, v22, v35
    v_dot2_f32_bf16 v32, v131, v23, v32
    v_dot2_f32_bf16 v33, v135, v23, v33
    v_dot2_f32_bf16 v34, v139, v23, v34
    v_dot2_f32_bf16 v35, v143, v23, v35
    buffer_load_dwordx4 v[128:131], v38, s[12:15], s81 offen nt
    s_add_u32 s81, s81, 0x10000
    buffer_load_dwordx4 v[132:135], v38, s[12:15], s81 offen nt
    s_add_u32 s81, s81, 0x10000
    buffer_load_dwordx4 v[136:139], v38, s[12:15], s81 offen nt
    s_add_u32 s81, s81, 0x10000
    v_add_f32_dpp v32, v32, v32 row_ror:8 row_mask:0xf bank_mask:0x3
    v_add_f32_dpp v32, v33, v33 row_ror:8 row_mask:0xf bank_mask:0xc
    v_add_f32_dpp v34, v34, v34 row_ror:8 row_mask:0xf bank_mask:0x3
    v_add_f32_dpp v34, v35, v35 row_ror:8 row_mask:0xf bank_mask:0xc
    buffer_load_dwordx4 v[140:143], v38, s[12:15], s81 offen nt
    v_add_f32_dpp v33, v32, v32 row_half_mirror row_mask:0xf bank_mask:0x5
    v_add_f32_dpp v33, v34, v34 row_half_mirror row_mask:0xf bank_mask:0xa
    s_nop 1
    v_add_f32_dpp v33, v33, v33 quad_perm:[1,0,3,2] row_mask:0xf bank_mask:0xf
    s_nop 1
    v_add_f32_dpp v33, v33, v33 quad_perm:[2,3,0,1] row_mask:0xf bank_mask:0xf
    s_nop 0
    v_max_f32 v40, v40, v33
    ds_write_b32 v41, v33 offset:64
    s_bfe_u32 s96, s99, 0x60000
    s_lshl_b32 s96, s96, 10
    s_bfe_u32 s97, s99, 0x10006
    s_lshl_b32 s97, s97, 19
    s_or_b32 s96, s96, s97
    s_bfe_u32 s97, s99, 0x10007
    s_lshl_b32 s97, s97, 18
    s_or_b32 s96, s96, s97
    s_bfe_u32 s97, s99, 0x30008
    s_lshl_b32 s97, s97, 20
    s_or_b32 s96, s96, s97
    s_add_u32 s96, s96, s84
    s_and_b32 s96, s96, 0x7fffff
    s_add_u32 s81, s96, s89
    s_add_u32 s99, s99, 1
    s_waitcnt vmcnt(6)
    v_dot2_f32_bf16 v32, v72, v20, 0
    v_dot2_f32_bf16 v33, v76, v20, 0
    v_dot2_f32_bf16 v34, v80, v20, 0
    v_dot2_f32_bf16 v35, v84, v20, 0
    v_dot2_f32_bf16 v32, v73, v21, v32
    v_dot2_f32_bf16 v33, v77, v21, v33
    v_dot2_f32_bf16 v34, v81, v21, v34
    v_dot2_f32_bf16 v35, v85, v21, v35
    v_dot2_f32_bf16 v32, v74, v22, v32
    v_dot2_f32_bf16 v33, v78, v22, v33
    v_dot2_f32_bf16 v34, v82, v22, v34
    v_dot2_f32_bf16 v35, v86, v22, v35
    v_dot2_f32_bf16 v32, v75, v23, v32
    v_dot2_f32_bf16 v33, v79, v23, v33
    v_dot2_f32_bf16 v34, v83, v23, v34
    v_dot2_f32_bf16 v35, v87, v23, v35
    buffer_load_dwordx4 v[72:75], v38, s[12:15], s81 offen nt
    s_add_u32 s81, s81, 0x10000
    buffer_load_dwordx4 v[76:79], v38, s[12:15], s81 offen nt
    s_add_u32 s81, s81, 0x10000
    buffer_load_dwordx4 v[80:83], v38, s[12:15], s81 offen nt
    s_add_u32 s81, s81, 0x10000
    v_add_f32_dpp v32, v32, v32 row_ror:8 row_mask:0xf bank_mask:0x3
    v_add_f32_dpp v32, v33, v33 row_ror:8 row_mask:0xf bank_mask:0xc
    v_add_f32_dpp v34, v34, v34 row_ror:8 row_mask:0xf bank_mask:0x3
    v_add_f32_dpp v34, v35, v35 row_ror:8 row_mask:0xf bank_mask:0xc
    buffer_load_dwordx4 v[84:87], v38, s[12:15], s81 offen nt
    v_add_f32_dpp v33, v32, v32 row_half_mirror row_mask:0xf bank_mask:0x5
    v_add_f32_dpp v33, v34, v34 row_half_mirror row_mask:0xf bank_mask:0xa
    s_nop 1
    v_add_f32_dpp v33, v33, v33 quad_perm:[1,0,3,2] row_mask:0xf bank_mask:0xf
    s_nop 1
    v_add_f32_dpp v33, v33, v33 quad_perm:[2,3,0,1] row_mask:0xf bank_mask:0xf
    s_nop 0
    v_max_f32 v40, v40, v33
    ds_write_b32 v41, v33 offset:128
    s_bfe_u32 s96, s99, 0x60000
    s_lshl_b32 s96, s96, 10
    s_bfe_u32 s97, s99, 0x10006
    s_lshl_b32 s97, s97, 19
    s_or_b32 s96, s96, s97
    s_bfe_u32 s97, s99, 0x10007
    s_lshl_b32 s97, s97, 18
    s_or_b32 s96, s96, s97
    s_bfe_u32 s97, s99, 0x30008
    s_lshl_b32 s97, s97, 20
    s_or_b32 s96, s96, s97
    s_add_u32 s96, s96, s84
    s_and_b32 s96, s96, 0x7fffff
    s_add_u32 s81, s96, s89
    s_add_u32 s99, s99, 125
    s_waitcnt vmcnt(6)
    v_dot2_f32_bf16 v32, v144, v20, 0
    v_dot2_f32_bf16 v33, v148, v20, 0
    v_dot2_f32_bf16 v34, v152, v20, 0
    v_dot2_f32_bf16 v35, v156, v20, 0
    v_dot2_f32_bf16 v32, v145, v21, v32
    v_dot2_f32_bf16 v33, v149, v21, v33
    v_dot2_f32_bf16 v34, v153, v21, v34
    v_dot2_f32_bf16 v35, v157, v21, v35
    v_dot2_f32_bf16 v32, v146, v22, v32
    v_dot2_f32_bf16 v33, v150, v22, v33
    v_dot2_f32_bf16 v34, v154, v22, v34
    v_dot2_f32_bf16 v35, v158, v22, v35
    v_dot2_f32_bf16 v32, v147, v23, v32
    v_dot2_f32_bf16 v33, v151, v23, v33
    v_dot2_f32_bf16 v34, v155, v23, v34
    v_dot2_f32_bf16 v35, v159, v23, v35
    buffer_load_dwordx4 v[144:147], v38, s[12:15], s81 offen nt
    s_add_u32 s81, s81, 0x10000
    buffer_load_dwordx4 v[148:151], v38, s[12:15], s81 offen nt
    s_add_u32 s81, s81, 0x10000
    buffer_load_dwordx4 v[152:155], v38, s[12:15], s81 offen nt
    s_add_u32 s81, s81, 0x10000
    v_add_f32_dpp v32, v32, v32 row_ror:8 row_mask:0xf bank_mask:0x3
    v_add_f32_dpp v32, v33, v33 row_ror:8 row_mask:0xf bank_mask:0xc
    v_add_f32_dpp v34, v34, v34 row_ror:8 row_mask:0xf bank_mask:0x3
    v_add_f32_dpp v34, v35, v35 row_ror:8 row_mask:0xf bank_mask:0xc
    buffer_load_dwordx4 v[156:159], v38, s[12:15], s81 offen nt
    v_add_f32_dpp v33, v32, v32 row_half_mirror row_mask:0xf bank_mask:0x5
    v_add_f32_dpp v33, v34, v34 row_half_mirror row_mask:0xf bank_mask:0xa
    s_nop 1
    v_add_f32_dpp v33, v33, v33 quad_perm:[1,0,3,2] row_mask:0xf bank_mask:0xf
    s_nop 1
    v_add_f32_dpp v33, v33, v33 quad_perm:[2,3,0,1] row_mask:0xf bank_mask:0xf
    s_nop 0
    v_max_f32 v40, v40, v33
    ds_write_b32 v41, v33 offset:192
    v_add_u32 v41, 256, v41
    s_add_u32 s100, s100, 1
    s_cmp_eq_u32 s100, 13
    s_cbranch_scc1 L_kend
L_k1:
    s_cmp_eq_u32 s100, 11
    s_cbranch_scc0 L_ksw1
    s_mov_b32 s12, s56
    s_and_b32 s13, s57, 0xffff
    s_mov_b32 s99, s98
L_ksw1:
    s_bfe_u32 s96, s99, 0x60000
    s_lshl_b32 s96, s96, 10
    s_bfe_u32 s97, s99, 0x10006
    s_lshl_b32 s97, s97, 19
    s_or_b32 s96, s96, s97
    s_bfe_u32 s97, s99, 0x10007
    s_lshl_b32 s97, s97, 18
    s_or_b32 s96, s96, s97
    s_bfe_u32 s97, s99, 0x30008
    s_lshl_b32 s97, s97, 20
    s_or_b32 s96, s96, s97
    s_add_u32 s96, s96, s84
    s_and_b32 s96, s96, 0x7fffff
    s_add_u32 s81, s96, s89
    s_add_u32 s99, s99, 1
    s_waitcnt vmcnt(6)
    v_dot2_f32_bf16 v32, v88, v20, 0
    v_dot2_f32_bf16 v33, v92, v20, 0
    v_dot2_f32_bf16 v34, v96, v20, 0
    v_dot2_f32_bf16 v35, v100, v20, 0
    v_dot2_f32_bf16 v32, v89, v21, v32
    v_dot2_f32_bf16 v33, v93, v21, v33
    v_dot2_f32_bf16 v34, v97, v21, v34
    v_dot2_f32_bf16 v35, v101, v21, v35
    v_dot2_f32_bf16 v32, v90, v22, v32
    v_dot2_f32_bf16 v33, v94, v22, v33
    v_dot2_f32_bf16 v34, v98, v22, v34
    v_dot2_f32_bf16 v35, v102, v22, v35
    v_dot2_f32_bf16 v32, v91, v23, v32
    v_dot2_f32_bf16 v33, v95, v23, v33
    v_dot2_f32_bf16 v34, v99, v23, v34
    v_dot2_f32_bf16 v35, v103, v23, v35
    buffer_load_dwordx4 v[88:91], v38, s[12:15], s81 offen nt
    s_add_u32 s81, s81, 0x10000
    buffer_load_dwordx4 v[92:95], v38, s[12:15], s81 offen nt
    s_add_u32 s81, s81, 0x10000
    buffer_load_dwordx4 v[96:99], v38, s[12:15], s81 offen nt
    s_add_u32 s81, s81, 0x10000
    v_add_f32_dpp v32, v32, v32 row_ror:8 row_mask:0xf bank_mask:0x3
    v_add_f32_dpp v32, v33, v33 row_ror:8 row_mask:0xf bank_mask:0xc
    v_add_f32_dpp v34, v34, v34 row_ror:8 row_mask:0xf bank_mask:0x3
    v_add_f32_dpp v34, v35, v35 row_ror:8 row_mask:0xf bank_mask:0xc
    buffer_load_dwordx4 v[100:103], v38, s[12:15], s81 offen nt
    v_add_f32_dpp v33, v32, v32 row_half_mirror row_mask:0xf bank_mask:0x5
    v_add_f32_dpp v33, v34, v34 row_half_mirror row_mask:0xf bank_mask:0xa
    s_nop 1
    v_add_f32_dpp v33, v33, v33 quad_perm:[1,0,3,2] row_mask:0xf bank_mask:0xf
    s_nop 1
    v_add_f32_dpp v33, v33, v33 quad_perm:[2,3,0,1] row_mask:0xf bank_mask:0xf
    s_nop 0
    v_max_f32 v40, v40, v33
    ds_write_b32 v41, v33 offset:0
    s_bfe_u32 s96, s99, 0x60000
    s_lshl_b32 s96, s96, 10
    s_bfe_u32 s97, s99, 0x10006
    s_lshl_b32 s97, s97, 19
    s_or_b32 s96, s96, s97
    s_bfe_u32 s97, s99, 0x10007
    s_lshl_b32 s97, s97, 18
    s_or_b32 s96, s96, s97
    s_bfe_u32 s97, s99, 0x30008
    s_lshl_b32 s97, s97, 20
    s_or_b32 s96, s96, s97
    s_add_u32 s96, s96, s84
    s_and_b32 s96, s96, 0x7fffff
    s_add_u32 s81, s96, s89
    s_add_u32 s99, s99, 1
    s_waitcnt vmcnt(6)
    v_dot2_f32_bf16 v32, v160, v20, 0
    v_dot2_f32_bf16 v33, v164, v20, 0
    v_dot2_f32_bf16 v34, v168, v20, 0
    v_dot2_f32_bf16 v35, v172, v20, 0
    v_dot2_f32_bf16 v32, v161, v21, v32
    v_dot2_f32_bf16 v33, v165, v21, v33
    v_dot2_f32_bf16 v34, v169, v21, v34
    v_dot2_f32_bf16 v35, v173, v21, v35
    v_dot2_f32_bf16 v32, v162, v22, v32
    v_dot2_f32_bf16 v33, v166, v22, v33
    v_dot2_f32_bf16 v34, v170, v22, v34
    v_dot2_f32_bf16 v35, v174, v22, v35
    v_dot2_f32_bf16 v32, v163, v23, v32
    v_dot2_f32_bf16 v33, v167, v23, v33
    v_dot2_f32_bf16 v34, v171, v23, v34
    v_dot2_f32_bf16 v35, v175, v23, v35
    buffer_load_dwordx4 v[160:163], v38, s[12:15], s81 offen nt
    s_add_u32 s81, s81, 0x10000
    buffer_load_dwordx4 v[164:167], v38, s[12:15], s81 offen nt
    s_add_u32 s81, s81, 0x10000
    buffer_load_dwordx4 v[168:171], v38, s[12:15], s81 offen nt
    s_add_u32 s81, s81, 0x10000
    v_add_f32_dpp v32, v32, v32 row_ror:8 row_mask:0xf bank_mask:0x3
    v_add_f32_dpp v32, v33, v33 row_ror:8 row_mask:0xf bank_mask:0xc
    v_add_f32_dpp v34, v34, v34 row_ror:8 row_mask:0xf bank_mask:0x3
    v_add_f32_dpp v34, v35, v35 row_ror:8 row_mask:0xf bank_mask:0xc
    buffer_load_dwordx4 v[172:175], v38, s[12:15], s81 offen nt
    v_add_f32_dpp v33, v32, v32 row_half_mirror row_mask:0xf bank_mask:0x5
    v_add_f32_dpp v33, v34, v34 row_half_mirror row_mask:0xf bank_mask:0xa
    s_nop 1
    v_add_f32_dpp v33, v33, v33 quad_perm:[1,0,3,2] row_mask:0xf bank_mask:0xf
    s_nop 1
    v_add_f32_dpp v33, v33, v33 quad_perm:[2,3,0,1] row_mask:0xf bank_mask:0xf
    s_nop 0
    v_max_f32 v40, v40, v33
    ds_write_b32 v41, v33 offset:64
    s_bfe_u32 s96, s99, 0x60000
    s_lshl_b32 s96, s96, 10
    s_bfe_u32 s97, s99, 0x10006
    s_lshl_b32 s97, s97, 19
    s_or_b32 s96, s96, s97
    s_bfe_u32 s97, s99, 0x10007
    s_lshl_b32 s97, s97, 18
    s_or_b32 s96, s96, s97
    s_bfe_u32 s97, s99, 0x30008
    s_lshl_b32 s97, s97, 20
    s_or_b32 s96, s96, s97
    s_add_u32 s96, s96, s84
    s_and_b32 s96, s96, 0x7fffff
    s_add_u32 s81, s96, s89
    s_add_u32 s99, s99, 1
    s_waitcnt vmcnt(6)
    v_dot2_f32_bf16 v32, v104, v20, 0
    v_dot2_f32_bf16 v33, v108, v20, 0
    v_dot2_f32_bf16 v34, v112, v20, 0
    v_dot2_f32_bf16 v35, v116, v20, 0
    v_dot2_f32_bf16 v32, v105, v21, v32
    v_dot2_f32_bf16 v33, v109, v21, v33
    v_dot2_f32_bf16 v34, v113, v21, v34
    v_dot2_f32_bf16 v35, v117, v21, v35
    v_dot2_f32_bf16 v32, v106, v22, v32
    v_dot2_f32_bf16 v33, v110, v22, v33
    v_dot2_f32_bf16 v34, v114, v22, v34
    v_dot2_f32_bf16 v35, v118, v22, v35
    v_dot2_f32_bf16 v32, v107, v23, v32
    v_dot2_f32_bf16 v33, v111, v23, v33
    v_dot2_f32_bf16 v34, v115, v23, v34
    v_dot2_f32_bf16 v35, v119, v23, v35
    buffer_load_dwordx4 v[104:107], v38, s[12:15], s81 offen nt
    s_add_u32 s81, s81, 0x10000
    buffer_load_dwordx4 v[108:111], v38, s[12:15], s81 offen nt
    s_add_u32 s81, s81, 0x10000
    buffer_load_dwordx4 v[112:115], v38, s[12:15], s81 offen nt
    s_add_u32 s81, s81, 0x10000
    v_add_f32_dpp v32, v32, v32 row_ror:8 row_mask:0xf bank_mask:0x3
    v_add_f32_dpp v32, v33, v33 row_ror:8 row_mask:0xf bank_mask:0xc
    v_add_f32_dpp v34, v34, v34 row_ror:8 row_mask:0xf bank_mask:0x3
    v_add_f32_dpp v34, v35, v35 row_ror:8 row_mask:0xf bank_mask:0xc
    buffer_load_dwordx4 v[116:119], v38, s[12:15], s81 offen nt
    v_add_f32_dpp v33, v32, v32 row_half_mirror row_mask:0xf bank_mask:0x5
    v_add_f32_dpp v33, v34, v34 row_half_mirror row_mask:0xf bank_mask:0xa
    s_nop 1
    v_add_f32_dpp v33, v33, v33 quad_perm:[1,0,3,2] row_mask:0xf bank_mask:0xf
    s_nop 1
    v_add_f32_dpp v33, v33, v33 quad_perm:[2,3,0,1] row_mask:0xf bank_mask:0xf
    s_nop 0
    v_max_f32 v40, v40, v33
    ds_write_b32 v41, v33 offset:128
    s_bfe_u32 s96, s99, 0x60000
    s_lshl_b32 s96, s96, 10
    s_bfe_u32 s97, s99, 0x10006
    s_lshl_b32 s97, s97, 19
    s_or_b32 s96, s96, s97
    s_bfe_u32 s97, s99, 0x10007
    s_lshl_b32 s97, s97, 18
    s_or_b32 s96, s96, s97
    s_bfe_u32 s97, s99, 0x30008
    s_lshl_b32 s97, s97, 20
    s_or_b32 s96, s96, s97
    s_add_u32 s96, s96, s84
    s_and_b32 s96, s96, 0x7fffff
    s_add_u32 s81, s96, s89
    s_add_u32 s99, s99, 125
    s_waitcnt vmcnt(6)
    v_dot2_f32_bf16 v32, v176, v20, 0
    v_dot2_f32_bf16 v33, v180, v20, 0
    v_dot2_f32_bf16 v34, v184, v20, 0
    v_dot2_f32_bf16 v35, v188, v20, 0
    v_dot2_f32_bf16 v32, v177, v21, v32
    v_dot2_f32_bf16 v33, v181, v21, v33
    v_dot2_f32_bf16 v34, v185, v21, v34
    v_dot2_f32_bf16 v35, v189, v21, v35
    v_dot2_f32_bf16 v32, v178, v22, v32
    v_dot2_f32_bf16 v33, v182, v22, v33
    v_dot2_f32_bf16 v34, v186, v22, v34
    v_dot2_f32_bf16 v35, v190, v22, v35
    v_dot2_f32_bf16 v32, v179, v23, v32
    v_dot2_f32_bf16 v33, v183, v23, v33
    v_dot2_f32_bf16 v34, v187, v23, v34
    v_dot2_f32_bf16 v35, v191, v23, v35
    buffer_load_dwordx4 v[176:179], v38, s[12:15], s81 offen nt
    s_add_u32 s81, s81, 0x10000
    buffer_load_dwordx4 v[180:183], v38, s[12:15], s81 offen nt
    s_add_u32 s81, s81, 0x10000
    buffer_load_dwordx4 v[184:187], v38, s[12:15], s81 offen nt
    s_add_u32 s81, s81, 0x10000
    v_add_f32_dpp v32, v32, v32 row_ror:8 row_mask:0xf bank_mask:0x3
    v_add_f32_dpp v32, v33, v33 row_ror:8 row_mask:0xf bank_mask:0xc
    v_add_f32_dpp v34, v34, v34 row_ror:8 row_mask:0xf bank_mask:0x3
    v_add_f32_dpp v34, v35, v35 row_ror:8 row_mask:0xf bank_mask:0xc
    buffer_load_dwordx4 v[188:191], v38, s[12:15], s81 offen nt
    v_add_f32_dpp v33, v32, v32 row_half_mirror row_mask:0xf bank_mask:0x5
    v_add_f32_dpp v33, v34, v34 row_half_mirror row_mask:0xf bank_mask:0xa
    s_nop 1
    v_add_f32_dpp v33, v33, v33 quad_perm:[1,0,3,2] row_mask:0xf bank_mask:0xf
    s_nop 1
    v_add_f32_dpp v33, v33, v33 quad_perm:[2,3,0,1] row_mask:0xf bank_mask:0xf
    s_nop 0
    v_max_f32 v40, v40, v33
    ds_write_b32 v41, v33 offset:192
    v_add_u32 v41, 256, v41
    s_add_u32 s100, s100, 1
    s_add_u32 s88, s88, 1
    s_branch L_k0
L_kend:
    s_nop 0
    v_max_f32_dpp v40, v40, v40 row_ror:4 row_mask:0xf bank_mask:0xf
    s_nop 1
    v_max_f32_dpp v40, v40, v40 row_ror:8 row_mask:0xf bank_mask:0xf
    s_nop 0
    v_mov_b32 v3, v40
    s_nop 1
    v_permlane16_swap_b32 v40, v3
    s_nop 0
    v_max_f32 v40, v40, v3
    s_nop 0
    v_mov_b32 v3, v40
    s_nop 1
    v_permlane32_swap_b32 v40, v3
    s_nop 0
    v_max_f32 v28, v40, v3
    v_subrev_u32 v193, 3328, v41
    ds_read_b32 v194, v193
    v_mul_f32 v29, s83, v28
    s_mov_b32 s100, 5
    s_branch L_v1
L_v0:
    s_bfe_u32 s96, s99, 0x60000
    s_lshl_b32 s96, s96, 10
    s_bfe_u32 s97, s99, 0x10006
    s_lshl_b32 s97, s97, 19
    s_or_b32 s96, s96, s97
    s_bfe_u32 s97, s99, 0x10007
    s_lshl_b32 s97, s97, 18
    s_or_b32 s96, s96, s97
    s_bfe_u32 s97, s99, 0x30008
    s_lshl_b32 s97, s97, 20
    s_or_b32 s96, s96, s97
    s_add_u32 s96, s96, s84
    s_and_b32 s96, s96, 0x7fffff
    s_add_u32 s81, s96, s89
    s_add_u32 s99, s99, 1
    s_waitcnt lgkmcnt(0)
    ds_read_b32 v195, v193 offset:64
    v_fma_f32 v36, v194, s83, -v29
    v_exp_f32 v36, v36
    s_nop 0
    v_cvt_pk_bf16_f32 v37, v36, v36
    v_add_f32 v30, v30, v36
    s_nop 0
    v_and_b32_dpp v40, v37, v16 row_newbcast:0 row_mask:0xf bank_mask:0xf
    v_and_b32_dpp v41, v37, v17 row_newbcast:0 row_mask:0xf bank_mask:0xf
    v_and_b32_dpp v42, v37, v18 row_newbcast:0 row_mask:0xf bank_mask:0xf
    v_and_b32_dpp v43, v37, v19 row_newbcast:0 row_mask:0xf bank_mask:0xf
    v_and_b32_dpp v44, v37, v16 row_newbcast:8 row_mask:0xf bank_mask:0xf
    v_and_b32_dpp v45, v37, v17 row_newbcast:8 row_mask:0xf bank_mask:0xf
    v_and_b32_dpp v46, v37, v18 row_newbcast:8 row_mask:0xf bank_mask:0xf
    v_and_b32_dpp v47, v37, v19 row_newbcast:8 row_mask:0xf bank_mask:0xf
    v_and_b32_dpp v48, v37, v16 row_newbcast:4 row_mask:0xf bank_mask:0xf
    v_and_b32_dpp v49, v37, v17 row_newbcast:4 row_mask:0xf bank_mask:0xf
    v_and_b32_dpp v50, v37, v18 row_newbcast:4 row_mask:0xf bank_mask:0xf
    v_and_b32_dpp v51, v37, v19 row_newbcast:4 row_mask:0xf bank_mask:0xf
    v_and_b32_dpp v52, v37, v16 row_newbcast:12 row_mask:0xf bank_mask:0xf
    v_and_b32_dpp v53, v37, v17 row_newbcast:12 row_mask:0xf bank_mask:0xf
    v_and_b32_dpp v54, v37, v18 row_newbcast:12 row_mask:0xf bank_mask:0xf
    v_and_b32_dpp v55, v37, v19 row_newbcast:12 row_mask:0xf bank_mask:0xf
    s_waitcnt vmcnt(6)
    v_mfma_f32_16x16x32_bf16 v[24:27], v[40:43], v[56:59], v[24:27]
    v_mfma_f32_16x16x32_bf16 v[24:27], v[44:47], v[60:63], v[24:27]
    v_mfma_f32_16x16x32_bf16 v[24:27], v[48:51], v[64:67], v[24:27]
    v_mfma_f32_16x16x32_bf16 v[24:27], v[52:55], v[68:71], v[24:27]
    buffer_load_dwordx4 v[56:59], v38, s[12:15], s81 offen nt
    s_add_u32 s81, s81, 0x10000
    buffer_load_dwordx4 v[60:63], v38, s[12:15], s81 offen nt
    s_add_u32 s81, s81, 0x10000
    buffer_load_dwordx4 v[64:67], v38, s[12:15], s81 offen nt
    s_add_u32 s81, s81, 0x10000
    buffer_load_dwordx4 v[68:71], v38, s[12:15], s81 offen nt
    s_bfe_u32 s96, s99, 0x60000
    s_lshl_b32 s96, s96, 10
    s_bfe_u32 s97, s99, 0x10006
    s_lshl_b32 s97, s97, 19
    s_or_b32 s96, s96, s97
    s_bfe_u32 s97, s99, 0x10007
    s_lshl_b32 s97, s97, 18
    s_or_b32 s96, s96, s97
    s_bfe_u32 s97, s99, 0x30008
    s_lshl_b32 s97, s97, 20
    s_or_b32 s96, s96, s97
    s_add_u32 s96, s96, s84
    s_and_b32 s96, s96, 0x7fffff
    s_add_u32 s81, s96, s89
    s_add_u32 s99, s99, 1
    s_waitcnt lgkmcnt(0)
    ds_read_b32 v194, v193 offset:128
    v_fma_f32 v36, v195, s83, -v29
    v_exp_f32 v36, v36
    s_nop 0
    v_cvt_pk_bf16_f32 v37, v36, v36
    v_add_f32 v30, v30, v36
    s_nop 0
    v_and_b32_dpp v40, v37, v16 row_newbcast:0 row_mask:0xf bank_mask:0xf
    v_and_b32_dpp v41, v37, v17 row_newbcast:0 row_mask:0xf bank_mask:0xf
    v_and_b32_dpp v42, v37, v18 row_newbcast:0 row_mask:0xf bank_mask:0xf
    v_and_b32_dpp v43, v37, v19 row_newbcast:0 row_mask:0xf bank_mask:0xf
    v_and_b32_dpp v44, v37, v16 row_newbcast:8 row_mask:0xf bank_mask:0xf
    v_and_b32_dpp v45, v37, v17 row_newbcast:8 row_mask:0xf bank_mask:0xf
    v_and_b32_dpp v46, v37, v18 row_newbcast:8 row_mask:0xf bank_mask:0xf
    v_and_b32_dpp v47, v37, v19 row_newbcast:8 row_mask:0xf bank_mask:0xf
    v_and_b32_dpp v48, v37, v16 row_newbcast:4 row_mask:0xf bank_mask:0xf
    v_and_b32_dpp v49, v37, v17 row_newbcast:4 row_mask:0xf bank_mask:0xf
    v_and_b32_dpp v50, v37, v18 row_newbcast:4 row_mask:0xf bank_mask:0xf
    v_and_b32_dpp v51, v37, v19 row_newbcast:4 row_mask:0xf bank_mask:0xf
    v_and_b32_dpp v52, v37, v16 row_newbcast:12 row_mask:0xf bank_mask:0xf
    v_and_b32_dpp v53, v37, v17 row_newbcast:12 row_mask:0xf bank_mask:0xf
    v_and_b32_dpp v54, v37, v18 row_newbcast:12 row_mask:0xf bank_mask:0xf
    v_and_b32_dpp v55, v37, v19 row_newbcast:12 row_mask:0xf bank_mask:0xf
    s_waitcnt vmcnt(6)
    v_mfma_f32_16x16x32_bf16 v[24:27], v[40:43], v[128:131], v[24:27]
    v_mfma_f32_16x16x32_bf16 v[24:27], v[44:47], v[132:135], v[24:27]
    v_mfma_f32_16x16x32_bf16 v[24:27], v[48:51], v[136:139], v[24:27]
    v_mfma_f32_16x16x32_bf16 v[24:27], v[52:55], v[140:143], v[24:27]
    buffer_load_dwordx4 v[128:131], v38, s[12:15], s81 offen nt
    s_add_u32 s81, s81, 0x10000
    buffer_load_dwordx4 v[132:135], v38, s[12:15], s81 offen nt
    s_add_u32 s81, s81, 0x10000
    buffer_load_dwordx4 v[136:139], v38, s[12:15], s81 offen nt
    s_add_u32 s81, s81, 0x10000
    buffer_load_dwordx4 v[140:143], v38, s[12:15], s81 offen nt
    s_bfe_u32 s96, s99, 0x60000
    s_lshl_b32 s96, s96, 10
    s_bfe_u32 s97, s99, 0x10006
    s_lshl_b32 s97, s97, 19
    s_or_b32 s96, s96, s97
    s_bfe_u32 s97, s99, 0x10007
    s_lshl_b32 s97, s97, 18
    s_or_b32 s96, s96, s97
    s_bfe_u32 s97, s99, 0x30008
    s_lshl_b32 s97, s97, 20
    s_or_b32 s96, s96, s97
    s_add_u32 s96, s96, s84
    s_and_b32 s96, s96, 0x7fffff
    s_add_u32 s81, s96, s89
    s_add_u32 s99, s99, 1
    s_waitcnt lgkmcnt(0)
    ds_read_b32 v195, v193 offset:192
    v_fma_f32 v36, v194, s83, -v29
    v_exp_f32 v36, v36
    s_nop 0
    v_cvt_pk_bf16_f32 v37, v36, v36
    v_add_f32 v30, v30, v36
    s_nop 0
    v_and_b32_dpp v40, v37, v16 row_newbcast:0 row_mask:0xf bank_mask:0xf
    v_and_b32_dpp v41, v37, v17 row_newbcast:0 row_mask:0xf bank_mask:0xf
    v_and_b32_dpp v42, v37, v18 row_newbcast:0 row_mask:0xf bank_mask:0xf
    v_and_b32_dpp v43, v37, v19 row_newbcast:0 row_mask:0xf bank_mask:0xf
    v_and_b32_dpp v44, v37, v16 row_newbcast:8 row_mask:0xf bank_mask:0xf
    v_and_b32_dpp v45, v37, v17 row_newbcast:8 row_mask:0xf bank_mask:0xf
    v_and_b32_dpp v46, v37, v18 row_newbcast:8 row_mask:0xf bank_mask:0xf
    v_and_b32_dpp v47, v37, v19 row_newbcast:8 row_mask:0xf bank_mask:0xf
    v_and_b32_dpp v48, v37, v16 row_newbcast:4 row_mask:0xf bank_mask:0xf
    v_and_b32_dpp v49, v37, v17 row_newbcast:4 row_mask:0xf bank_mask:0xf
    v_and_b32_dpp v50, v37, v18 row_newbcast:4 row_mask:0xf bank_mask:0xf
    v_and_b32_dpp v51, v37, v19 row_newbcast:4 row_mask:0xf bank_mask:0xf
    v_and_b32_dpp v52, v37, v16 row_newbcast:12 row_mask:0xf bank_mask:0xf
    v_and_b32_dpp v53, v37, v17 row_newbcast:12 row_mask:0xf bank_mask:0xf
    v_and_b32_dpp v54, v37, v18 row_newbcast:12 row_mask:0xf bank_mask:0xf
    v_and_b32_dpp v55, v37, v19 row_newbcast:12 row_mask:0xf bank_mask:0xf
    s_waitcnt vmcnt(6)
    v_mfma_f32_16x16x32_bf16 v[24:27], v[40:43], v[72:75], v[24:27]
    v_mfma_f32_16x16x32_bf16 v[24:27], v[44:47], v[76:79], v[24:27]
    v_mfma_f32_16x16x32_bf16 v[24:27], v[48:51], v[80:83], v[24:27]
    v_mfma_f32_16x16x32_bf16 v[24:27], v[52:55], v[84:87], v[24:27]
    buffer_load_dwordx4 v[72:75], v38, s[12:15], s81 offen nt
    s_add_u32 s81, s81, 0x10000
    buffer_load_dwordx4 v[76:79], v38, s[12:15], s81 offen nt
    s_add_u32 s81, s81, 0x10000
    buffer_load_dwordx4 v[80:83], v38, s[12:15], s81 offen nt
    s_add_u32 s81, s81, 0x10000
    buffer_load_dwordx4 v[84:87], v38, s[12:15], s81 offen nt
    s_bfe_u32 s96, s99, 0x60000
    s_lshl_b32 s96, s96, 10
    s_bfe_u32 s97, s99, 0x10006
    s_lshl_b32 s97, s97, 19
    s_or_b32 s96, s96, s97
    s_bfe_u32 s97, s99, 0x10007
    s_lshl_b32 s97, s97, 18
    s_or_b32 s96, s96, s97
    s_bfe_u32 s97, s99, 0x30008
    s_lshl_b32 s97, s97, 20
    s_or_b32 s96, s96, s97
    s_add_u32 s96, s96, s84
    s_and_b32 s96, s96, 0x7fffff
    s_add_u32 s81, s96, s89
    s_add_u32 s99, s99, 125
    s_waitcnt lgkmcnt(0)
    ds_read_b32 v194, v193 offset:256
    v_fma_f32 v36, v195, s83, -v29
    v_exp_f32 v36, v36
    s_nop 0
    v_cvt_pk_bf16_f32 v37, v36, v36
    v_add_f32 v30, v30, v36
    s_nop 0
    v_and_b32_dpp v40, v37, v16 row_newbcast:0 row_mask:0xf bank_mask:0xf
    v_and_b32_dpp v41, v37, v17 row_newbcast:0 row_mask:0xf bank_mask:0xf
    v_and_b32_dpp v42, v37, v18 row_newbcast:0 row_mask:0xf bank_mask:0xf
    v_and_b32_dpp v43, v37, v19 row_newbcast:0 row_mask:0xf bank_mask:0xf
    v_and_b32_dpp v44, v37, v16 row_newbcast:8 row_mask:0xf bank_mask:0xf
    v_and_b32_dpp v45, v37, v17 row_newbcast:8 row_mask:0xf bank_mask:0xf
    v_and_b32_dpp v46, v37, v18 row_newbcast:8 row_mask:0xf bank_mask:0xf
    v_and_b32_dpp v47, v37, v19 row_newbcast:8 row_mask:0xf bank_mask:0xf
    v_and_b32_dpp v48, v37, v16 row_newbcast:4 row_mask:0xf bank_mask:0xf
    v_and_b32_dpp v49, v37, v17 row_newbcast:4 row_mask:0xf bank_mask:0xf
    v_and_b32_dpp v50, v37, v18 row_newbcast:4 row_mask:0xf bank_mask:0xf
    v_and_b32_dpp v51, v37, v19 row_newbcast:4 row_mask:0xf bank_mask:0xf
    v_and_b32_dpp v52, v37, v16 row_newbcast:12 row_mask:0xf bank_mask:0xf
    v_and_b32_dpp v53, v37, v17 row_newbcast:12 row_mask:0xf bank_mask:0xf
    v_and_b32_dpp v54, v37, v18 row_newbcast:12 row_mask:0xf bank_mask:0xf
    v_and_b32_dpp v55, v37, v19 row_newbcast:12 row_mask:0xf bank_mask:0xf
    s_waitcnt vmcnt(6)
    v_mfma_f32_16x16x32_bf16 v[24:27], v[40:43], v[144:147], v[24:27]
    v_mfma_f32_16x16x32_bf16 v[24:27], v[44:47], v[148:151], v[24:27]
    v_mfma_f32_16x16x32_bf16 v[24:27], v[48:51], v[152:155], v[24:27]
    v_mfma_f32_16x16x32_bf16 v[24:27], v[52:55], v[156:159], v[24:27]
    buffer_load_dwordx4 v[144:147], v38, s[12:15], s81 offen nt
    s_add_u32 s81, s81, 0x10000
    buffer_load_dwordx4 v[148:151], v38, s[12:15], s81 offen nt
    s_add_u32 s81, s81, 0x10000
    buffer_load_dwordx4 v[152:155], v38, s[12:15], s81 offen nt
    s_add_u32 s81, s81, 0x10000
    buffer_load_dwordx4 v[156:159], v38, s[12:15], s81 offen nt
    v_add_u32 v193, 256, v193
    s_sub_u32 s100, s100, 1
L_v1:
    s_bfe_u32 s96, s99, 0x60000
    s_lshl_b32 s96, s96, 10
    s_bfe_u32 s97, s99, 0x10006
    s_lshl_b32 s97, s97, 19
    s_or_b32 s96, s96, s97
    s_bfe_u32 s97, s99, 0x10007
    s_lshl_b32 s97, s97, 18
    s_or_b32 s96, s96, s97
    s_bfe_u32 s97, s99, 0x30008
    s_lshl_b32 s97, s97, 20
    s_or_b32 s96, s96, s97
    s_add_u32 s96, s96, s84
    s_and_b32 s96, s96, 0x7fffff
    s_add_u32 s81, s96, s89
    s_add_u32 s99, s99, 1
    s_waitcnt lgkmcnt(0)
    ds_read_b32 v195, v193 offset:64
    v_fma_f32 v36, v194, s83, -v29
    v_exp_f32 v36, v36
    s_nop 0
    v_cvt_pk_bf16_f32 v37, v36, v36
    v_add_f32 v30, v30, v36
    s_nop 0
    v_and_b32_dpp v40, v37, v16 row_newbcast:0 row_mask:0xf bank_mask:0xf
    v_and_b32_dpp v41, v37, v17 row_newbcast:0 row_mask:0xf bank_mask:0xf
    v_and_b32_dpp v42, v37, v18 row_newbcast:0 row_mask:0xf bank_mask:0xf
    v_and_b32_dpp v43, v37, v19 row_newbcast:0 row_mask:0xf bank_mask:0xf
    v_and_b32_dpp v44, v37, v16 row_newbcast:8 row_mask:0xf bank_mask:0xf
    v_and_b32_dpp v45, v37, v17 row_newbcast:8 row_mask:0xf bank_mask:0xf
    v_and_b32_dpp v46, v37, v18 row_newbcast:8 row_mask:0xf bank_mask:0xf
    v_and_b32_dpp v47, v37, v19 row_newbcast:8 row_mask:0xf bank_mask:0xf
    v_and_b32_dpp v48, v37, v16 row_newbcast:4 row_mask:0xf bank_mask:0xf
    v_and_b32_dpp v49, v37, v17 row_newbcast:4 row_mask:0xf bank_mask:0xf
    v_and_b32_dpp v50, v37, v18 row_newbcast:4 row_mask:0xf bank_mask:0xf
    v_and_b32_dpp v51, v37, v19 row_newbcast:4 row_mask:0xf bank_mask:0xf
    v_and_b32_dpp v52, v37, v16 row_newbcast:12 row_mask:0xf bank_mask:0xf
    v_and_b32_dpp v53, v37, v17 row_newbcast:12 row_mask:0xf bank_mask:0xf
    v_and_b32_dpp v54, v37, v18 row_newbcast:12 row_mask:0xf bank_mask:0xf
    v_and_b32_dpp v55, v37, v19 row_newbcast:12 row_mask:0xf bank_mask:0xf
    s_waitcnt vmcnt(6)
    v_mfma_f32_16x16x32_bf16 v[24:27], v[40:43], v[88:91], v[24:27]
    v_mfma_f32_16x16x32_bf16 v[24:27], v[44:47], v[92:95], v[24:27]
    v_mfma_f32_16x16x32_bf16 v[24:27], v[48:51], v[96:99], v[24:27]
    v_mfma_f32_16x16x32_bf16 v[24:27], v[52:55], v[100:103], v[24:27]
    buffer_load_dwordx4 v[88:91], v38, s[12:15], s81 offen nt
    s_add_u32 s81, s81, 0x10000
    buffer_load_dwordx4 v[92:95], v38, s[12:15], s81 offen nt
    s_add_u32 s81, s81, 0x10000
    buffer_load_dwordx4 v[96:99], v38, s[12:15], s81 offen nt
    s_add_u32 s81, s81, 0x10000
    buffer_load_dwordx4 v[100:103], v38, s[12:15], s81 offen nt
    s_bfe_u32 s96, s99, 0x60000
    s_lshl_b32 s96, s96, 10
    s_bfe_u32 s97, s99, 0x10006
    s_lshl_b32 s97, s97, 19
    s_or_b32 s96, s96, s97
    s_bfe_u32 s97, s99, 0x10007
    s_lshl_b32 s97, s97, 18
    s_or_b32 s96, s96, s97
    s_bfe_u32 s97, s99, 0x30008
    s_lshl_b32 s97, s97, 20
    s_or_b32 s96, s96, s97
    s_add_u32 s96, s96, s84
    s_and_b32 s96, s96, 0x7fffff
    s_add_u32 s81, s96, s89
    s_add_u32 s99, s99, 1
    s_waitcnt lgkmcnt(0)
    ds_read_b32 v194, v193 offset:128
    v_fma_f32 v36, v195, s83, -v29
    v_exp_f32 v36, v36
    s_nop 0
    v_cvt_pk_bf16_f32 v37, v36, v36
    v_add_f32 v30, v30, v36
    s_nop 0
    v_and_b32_dpp v40, v37, v16 row_newbcast:0 row_mask:0xf bank_mask:0xf
    v_and_b32_dpp v41, v37, v17 row_newbcast:0 row_mask:0xf bank_mask:0xf
    v_and_b32_dpp v42, v37, v18 row_newbcast:0 row_mask:0xf bank_mask:0xf
    v_and_b32_dpp v43, v37, v19 row_newbcast:0 row_mask:0xf bank_mask:0xf
    v_and_b32_dpp v44, v37, v16 row_newbcast:8 row_mask:0xf bank_mask:0xf
    v_and_b32_dpp v45, v37, v17 row_newbcast:8 row_mask:0xf bank_mask:0xf
    v_and_b32_dpp v46, v37, v18 row_newbcast:8 row_mask:0xf bank_mask:0xf
    v_and_b32_dpp v47, v37, v19 row_newbcast:8 row_mask:0xf bank_mask:0xf
    v_and_b32_dpp v48, v37, v16 row_newbcast:4 row_mask:0xf bank_mask:0xf
    v_and_b32_dpp v49, v37, v17 row_newbcast:4 row_mask:0xf bank_mask:0xf
    v_and_b32_dpp v50, v37, v18 row_newbcast:4 row_mask:0xf bank_mask:0xf
    v_and_b32_dpp v51, v37, v19 row_newbcast:4 row_mask:0xf bank_mask:0xf
    v_and_b32_dpp v52, v37, v16 row_newbcast:12 row_mask:0xf bank_mask:0xf
    v_and_b32_dpp v53, v37, v17 row_newbcast:12 row_mask:0xf bank_mask:0xf
    v_and_b32_dpp v54, v37, v18 row_newbcast:12 row_mask:0xf bank_mask:0xf
    v_and_b32_dpp v55, v37, v19 row_newbcast:12 row_mask:0xf bank_mask:0xf
    s_waitcnt vmcnt(6)
    v_mfma_f32_16x16x32_bf16 v[24:27], v[40:43], v[160:163], v[24:27]
    v_mfma_f32_16x16x32_bf16 v[24:27], v[44:47], v[164:167], v[24:27]
    v_mfma_f32_16x16x32_bf16 v[24:27], v[48:51], v[168:171], v[24:27]
    v_mfma_f32_16x16x32_bf16 v[24:27], v[52:55], v[172:175], v[24:27]
    buffer_load_dwordx4 v[160:163], v38, s[12:15], s81 offen nt
    s_add_u32 s81, s81, 0x10000
    buffer_load_dwordx4 v[164:167], v38, s[12:15], s81 offen nt
    s_add_u32 s81, s81, 0x10000
    buffer_load_dwordx4 v[168:171], v38, s[12:15], s81 offen nt
    s_add_u32 s81, s81, 0x10000
    buffer_load_dwordx4 v[172:175], v38, s[12:15], s81 offen nt
    s_bfe_u32 s96, s99, 0x60000
    s_lshl_b32 s96, s96, 10
    s_bfe_u32 s97, s99, 0x10006
    s_lshl_b32 s97, s97, 19
    s_or_b32 s96, s96, s97
    s_bfe_u32 s97, s99, 0x10007
    s_lshl_b32 s97, s97, 18
    s_or_b32 s96, s96, s97
    s_bfe_u32 s97, s99, 0x30008
    s_lshl_b32 s97, s97, 20
    s_or_b32 s96, s96, s97
    s_add_u32 s96, s96, s84
    s_and_b32 s96, s96, 0x7fffff
    s_add_u32 s81, s96, s89
    s_add_u32 s99, s99, 1
    s_waitcnt lgkmcnt(0)
    ds_read_b32 v195, v193 offset:192
    v_fma_f32 v36, v194, s83, -v29
    v_exp_f32 v36, v36
    s_nop 0
    v_cvt_pk_bf16_f32 v37, v36, v36
    v_add_f32 v30, v30, v36
    s_nop 0
    v_and_b32_dpp v40, v37, v16 row_newbcast:0 row_mask:0xf bank_mask:0xf
    v_and_b32_dpp v41, v37, v17 row_newbcast:0 row_mask:0xf bank_mask:0xf
    v_and_b32_dpp v42, v37, v18 row_newbcast:0 row_mask:0xf bank_mask:0xf
    v_and_b32_dpp v43, v37, v19 row_newbcast:0 row_mask:0xf bank_mask:0xf
    v_and_b32_dpp v44, v37, v16 row_newbcast:8 row_mask:0xf bank_mask:0xf
    v_and_b32_dpp v45, v37, v17 row_newbcast:8 row_mask:0xf bank_mask:0xf
    v_and_b32_dpp v46, v37, v18 row_newbcast:8 row_mask:0xf bank_mask:0xf
    v_and_b32_dpp v47, v37, v19 row_newbcast:8 row_mask:0xf bank_mask:0xf
    v_and_b32_dpp v48, v37, v16 row_newbcast:4 row_mask:0xf bank_mask:0xf
    v_and_b32_dpp v49, v37, v17 row_newbcast:4 row_mask:0xf bank_mask:0xf
    v_and_b32_dpp v50, v37, v18 row_newbcast:4 row_mask:0xf bank_mask:0xf
    v_and_b32_dpp v51, v37, v19 row_newbcast:4 row_mask:0xf bank_mask:0xf
    v_and_b32_dpp v52, v37, v16 row_newbcast:12 row_mask:0xf bank_mask:0xf
    v_and_b32_dpp v53, v37, v17 row_newbcast:12 row_mask:0xf bank_mask:0xf
    v_and_b32_dpp v54, v37, v18 row_newbcast:12 row_mask:0xf bank_mask:0xf
    v_and_b32_dpp v55, v37, v19 row_newbcast:12 row_mask:0xf bank_mask:0xf
    s_waitcnt vmcnt(6)
    v_mfma_f32_16x16x32_bf16 v[24:27], v[40:43], v[104:107], v[24:27]
    v_mfma_f32_16x16x32_bf16 v[24:27], v[44:47], v[108:111], v[24:27]
    v_mfma_f32_16x16x32_bf16 v[24:27], v[48:51], v[112:115], v[24:27]
    v_mfma_f32_16x16x32_bf16 v[24:27], v[52:55], v[116:119], v[24:27]
    buffer_load_dwordx4 v[104:107], v38, s[12:15], s81 offen nt
    s_add_u32 s81, s81, 0x10000
    buffer_load_dwordx4 v[108:111], v38, s[12:15], s81 offen nt
    s_add_u32 s81, s81, 0x10000
    buffer_load_dwordx4 v[112:115], v38, s[12:15], s81 offen nt
    s_add_u32 s81, s81, 0x10000
    buffer_load_dwordx4 v[116:119], v38, s[12:15], s81 offen nt
    s_bfe_u32 s96, s99, 0x60000
    s_lshl_b32 s96, s96, 10
    s_bfe_u32 s97, s99, 0x10006
    s_lshl_b32 s97, s97, 19
    s_or_b32 s96, s96, s97
    s_bfe_u32 s97, s99, 0x10007
    s_lshl_b32 s97, s97, 18
    s_or_b32 s96, s96, s97
    s_bfe_u32 s97, s99, 0x30008
    s_lshl_b32 s97, s97, 20
    s_or_b32 s96, s96, s97
    s_add_u32 s96, s96, s84
    s_and_b32 s96, s96, 0x7fffff
    s_add_u32 s81, s96, s89
    s_add_u32 s99, s99, 125
    s_waitcnt lgkmcnt(0)
    ds_read_b32 v194, v193 offset:256
    v_fma_f32 v36, v195, s83, -v29
    v_exp_f32 v36, v36
    s_nop 0
    v_cvt_pk_bf16_f32 v37, v36, v36
    v_add_f32 v30, v30, v36
    s_nop 0
    v_and_b32_dpp v40, v37, v16 row_newbcast:0 row_mask:0xf bank_mask:0xf
    v_and_b32_dpp v41, v37, v17 row_newbcast:0 row_mask:0xf bank_mask:0xf
    v_and_b32_dpp v42, v37, v18 row_newbcast:0 row_mask:0xf bank_mask:0xf
    v_and_b32_dpp v43, v37, v19 row_newbcast:0 row_mask:0xf bank_mask:0xf
    v_and_b32_dpp v44, v37, v16 row_newbcast:8 row_mask:0xf bank_mask:0xf
    v_and_b32_dpp v45, v37, v17 row_newbcast:8 row_mask:0xf bank_mask:0xf
    v_and_b32_dpp v46, v37, v18 row_newbcast:8 row_mask:0xf bank_mask:0xf
    v_and_b32_dpp v47, v37, v19 row_newbcast:8 row_mask:0xf bank_mask:0xf
    v_and_b32_dpp v48, v37, v16 row_newbcast:4 row_mask:0xf bank_mask:0xf
    v_and_b32_dpp v49, v37, v17 row_newbcast:4 row_mask:0xf bank_mask:0xf
    v_and_b32_dpp v50, v37, v18 row_newbcast:4 row_mask:0xf bank_mask:0xf
    v_and_b32_dpp v51, v37, v19 row_newbcast:4 row_mask:0xf bank_mask:0xf
    v_and_b32_dpp v52, v37, v16 row_newbcast:12 row_mask:0xf bank_mask:0xf
    v_and_b32_dpp v53, v37, v17 row_newbcast:12 row_mask:0xf bank_mask:0xf
    v_and_b32_dpp v54, v37, v18 row_newbcast:12 row_mask:0xf bank_mask:0xf
    v_and_b32_dpp v55, v37, v19 row_newbcast:12 row_mask:0xf bank_mask:0xf
    s_waitcnt vmcnt(6)
    v_mfma_f32_16x16x32_bf16 v[24:27], v[40:43], v[176:179], v[24:27]
    v_mfma_f32_16x16x32_bf16 v[24:27], v[44:47], v[180:183], v[24:27]
    v_mfma_f32_16x16x32_bf16 v[24:27], v[48:51], v[184:187], v[24:27]
    v_mfma_f32_16x16x32_bf16 v[24:27], v[52:55], v[188:191], v[24:27]
    buffer_load_dwordx4 v[176:179], v38, s[12:15], s81 offen nt
    s_add_u32 s81, s81, 0x10000
    buffer_load_dwordx4 v[180:183], v38, s[12:15], s81 offen nt
    s_add_u32 s81, s81, 0x10000
    buffer_load_dwordx4 v[184:187], v38, s[12:15], s81 offen nt
    s_add_u32 s81, s81, 0x10000
    buffer_load_dwordx4 v[188:191], v38, s[12:15], s81 offen nt
    v_add_u32 v193, 256, v193
    s_add_u32 s88, s88, 1
    s_cmp_lg_u32 s100, 0
    s_cbranch_scc1 L_v0
    s_waitcnt lgkmcnt(0)
    ds_read_b32 v195, v193 offset:64
    v_fma_f32 v36, v194, s83, -v29
    v_exp_f32 v36, v36
    s_nop 0
    v_cvt_pk_bf16_f32 v37, v36, v36
    v_add_f32 v30, v30, v36
    s_nop 0
    v_and_b32_dpp v40, v37, v16 row_newbcast:0 row_mask:0xf bank_mask:0xf
    v_and_b32_dpp v41, v37, v17 row_newbcast:0 row_mask:0xf bank_mask:0xf
    v_and_b32_dpp v42, v37, v18 row_newbcast:0 row_mask:0xf bank_mask:0xf
    v_and_b32_dpp v43, v37, v19 row_newbcast:0 row_mask:0xf bank_mask:0xf
    v_and_b32_dpp v44, v37, v16 row_newbcast:8 row_mask:0xf bank_mask:0xf
    v_and_b32_dpp v45, v37, v17 row_newbcast:8 row_mask:0xf bank_mask:0xf
    v_and_b32_dpp v46, v37, v18 row_newbcast:8 row_mask:0xf bank_mask:0xf
    v_and_b32_dpp v47, v37, v19 row_newbcast:8 row_mask:0xf bank_mask:0xf
    v_and_b32_dpp v48, v37, v16 row_newbcast:4 row_mask:0xf bank_mask:0xf
    v_and_b32_dpp v49, v37, v17 row_newbcast:4 row_mask:0xf bank_mask:0xf
    v_and_b32_dpp v50, v37, v18 row_newbcast:4 row_mask:0xf bank_mask:0xf
    v_and_b32_dpp v51, v37, v19 row_newbcast:4 row_mask:0xf bank_mask:0xf
    v_and_b32_dpp v52, v37, v16 row_newbcast:12 row_mask:0xf bank_mask:0xf
    v_and_b32_dpp v53, v37, v17 row_newbcast:12 row_mask:0xf bank_mask:0xf
    v_and_b32_dpp v54, v37, v18 row_newbcast:12 row_mask:0xf bank_mask:0xf
    v_and_b32_dpp v55, v37, v19 row_newbcast:12 row_mask:0xf bank_mask:0xf
    s_waitcnt vmcnt(28)
    v_mfma_f32_16x16x32_bf16 v[24:27], v[40:43], v[56:59], v[24:27]
    v_mfma_f32_16x16x32_bf16 v[24:27], v[44:47], v[60:63], v[24:27]
    v_mfma_f32_16x16x32_bf16 v[24:27], v[48:51], v[64:67], v[24:27]
    v_mfma_f32_16x16x32_bf16 v[24:27], v[52:55], v[68:71], v[24:27]
    s_waitcnt lgkmcnt(0)
    ds_read_b32 v194, v193 offset:128
    v_fma_f32 v36, v195, s83, -v29
    v_exp_f32 v36, v36
    s_nop 0
    v_cvt_pk_bf16_f32 v37, v36, v36
    v_add_f32 v30, v30, v36
    s_nop 0
    v_and_b32_dpp v40, v37, v16 row_newbcast:0 row_mask:0xf bank_mask:0xf
    v_and_b32_dpp v41, v37, v17 row_newbcast:0 row_mask:0xf bank_mask:0xf
    v_and_b32_dpp v42, v37, v18 row_newbcast:0 row_mask:0xf bank_mask:0xf
    v_and_b32_dpp v43, v37, v19 row_newbcast:0 row_mask:0xf bank_mask:0xf
    v_and_b32_dpp v44, v37, v16 row_newbcast:8 row_mask:0xf bank_mask:0xf
    v_and_b32_dpp v45, v37, v17 row_newbcast:8 row_mask:0xf bank_mask:0xf
    v_and_b32_dpp v46, v37, v18 row_newbcast:8 row_mask:0xf bank_mask:0xf
    v_and_b32_dpp v47, v37, v19 row_newbcast:8 row_mask:0xf bank_mask:0xf
    v_and_b32_dpp v48, v37, v16 row_newbcast:4 row_mask:0xf bank_mask:0xf
    v_and_b32_dpp v49, v37, v17 row_newbcast:4 row_mask:0xf bank_mask:0xf
    v_and_b32_dpp v50, v37, v18 row_newbcast:4 row_mask:0xf bank_mask:0xf
    v_and_b32_dpp v51, v37, v19 row_newbcast:4 row_mask:0xf bank_mask:0xf
    v_and_b32_dpp v52, v37, v16 row_newbcast:12 row_mask:0xf bank_mask:0xf
    v_and_b32_dpp v53, v37, v17 row_newbcast:12 row_mask:0xf bank_mask:0xf
    v_and_b32_dpp v54, v37, v18 row_newbcast:12 row_mask:0xf bank_mask:0xf
    v_and_b32_dpp v55, v37, v19 row_newbcast:12 row_mask:0xf bank_mask:0xf
    s_waitcnt vmcnt(24)
    v_mfma_f32_16x16x32_bf16 v[24:27], v[40:43], v[128:131], v[24:27]
    v_mfma_f32_16x16x32_bf16 v[24:27], v[44:47], v[132:135], v[24:27]
    v_mfma_f32_16x16x32_bf16 v[24:27], v[48:51], v[136:139], v[24:27]
    v_mfma_f32_16x16x32_bf16 v[24:27], v[52:55], v[140:143], v[24:27]
    s_waitcnt lgkmcnt(0)
    ds_read_b32 v195, v193 offset:192
    v_fma_f32 v36, v194, s83, -v29
    v_exp_f32 v36, v36
    s_nop 0
    v_cvt_pk_bf16_f32 v37, v36, v36
    v_add_f32 v30, v30, v36
    s_nop 0
    v_and_b32_dpp v40, v37, v16 row_newbcast:0 row_mask:0xf bank_mask:0xf
    v_and_b32_dpp v41, v37, v17 row_newbcast:0 row_mask:0xf bank_mask:0xf
    v_and_b32_dpp v42, v37, v18 row_newbcast:0 row_mask:0xf bank_mask:0xf
    v_and_b32_dpp v43, v37, v19 row_newbcast:0 row_mask:0xf bank_mask:0xf
    v_and_b32_dpp v44, v37, v16 row_newbcast:8 row_mask:0xf bank_mask:0xf
    v_and_b32_dpp v45, v37, v17 row_newbcast:8 row_mask:0xf bank_mask:0xf
    v_and_b32_dpp v46, v37, v18 row_newbcast:8 row_mask:0xf bank_mask:0xf
    v_and_b32_dpp v47, v37, v19 row_newbcast:8 row_mask:0xf bank_mask:0xf
    v_and_b32_dpp v48, v37, v16 row_newbcast:4 row_mask:0xf bank_mask:0xf
    v_and_b32_dpp v49, v37, v17 row_newbcast:4 row_mask:0xf bank_mask:0xf
    v_and_b32_dpp v50, v37, v18 row_newbcast:4 row_mask:0xf bank_mask:0xf
    v_and_b32_dpp v51, v37, v19 row_newbcast:4 row_mask:0xf bank_mask:0xf
    v_and_b32_dpp v52, v37, v16 row_newbcast:12 row_mask:0xf bank_mask:0xf
    v_and_b32_dpp v53, v37, v17 row_newbcast:12 row_mask:0xf bank_mask:0xf
    v_and_b32_dpp v54, v37, v18 row_newbcast:12 row_mask:0xf bank_mask:0xf
    v_and_b32_dpp v55, v37, v19 row_newbcast:12 row_mask:0xf bank_mask:0xf
    s_waitcnt vmcnt(20)
    v_mfma_f32_16x16x32_bf16 v[24:27], v[40:43], v[72:75], v[24:27]
    v_mfma_f32_16x16x32_bf16 v[24:27], v[44:47], v[76:79], v[24:27]
    v_mfma_f32_16x16x32_bf16 v[24:27], v[48:51], v[80:83], v[24:27]
    v_mfma_f32_16x16x32_bf16 v[24:27], v[52:55], v[84:87], v[24:27]
    s_waitcnt lgkmcnt(0)
    ds_read_b32 v194, v193 offset:256
    v_fma_f32 v36, v195, s83, -v29
    v_exp_f32 v36, v36
    s_nop 0
    v_cvt_pk_bf16_f32 v37, v36, v36
    v_add_f32 v30, v30, v36
    s_nop 0
    v_and_b32_dpp v40, v37, v16 row_newbcast:0 row_mask:0xf bank_mask:0xf
    v_and_b32_dpp v41, v37, v17 row_newbcast:0 row_mask:0xf bank_mask:0xf
    v_and_b32_dpp v42, v37, v18 row_newbcast:0 row_mask:0xf bank_mask:0xf
    v_and_b32_dpp v43, v37, v19 row_newbcast:0 row_mask:0xf bank_mask:0xf
    v_and_b32_dpp v44, v37, v16 row_newbcast:8 row_mask:0xf bank_mask:0xf
    v_and_b32_dpp v45, v37, v17 row_newbcast:8 row_mask:0xf bank_mask:0xf
    v_and_b32_dpp v46, v37, v18 row_newbcast:8 row_mask:0xf bank_mask:0xf
    v_and_b32_dpp v47, v37, v19 row_newbcast:8 row_mask:0xf bank_mask:0xf
    v_and_b32_dpp v48, v37, v16 row_newbcast:4 row_mask:0xf bank_mask:0xf
    v_and_b32_dpp v49, v37, v17 row_newbcast:4 row_mask:0xf bank_mask:0xf
    v_and_b32_dpp v50, v37, v18 row_newbcast:4 row_mask:0xf bank_mask:0xf
    v_and_b32_dpp v51, v37, v19 row_newbcast:4 row_mask:0xf bank_mask:0xf
    v_and_b32_dpp v52, v37, v16 row_newbcast:12 row_mask:0xf bank_mask:0xf
    v_and_b32_dpp v53, v37, v17 row_newbcast:12 row_mask:0xf bank_mask:0xf
    v_and_b32_dpp v54, v37, v18 row_newbcast:12 row_mask:0xf bank_mask:0xf
    v_and_b32_dpp v55, v37, v19 row_newbcast:12 row_mask:0xf bank_mask:0xf
    s_waitcnt vmcnt(16)
    v_mfma_f32_16x16x32_bf16 v[24:27], v[40:43], v[144:147], v[24:27]
    v_mfma_f32_16x16x32_bf16 v[24:27], v[44:47], v[148:151], v[24:27]
    v_mfma_f32_16x16x32_bf16 v[24:27], v[48:51], v[152:155], v[24:27]
    v_mfma_f32_16x16x32_bf16 v[24:27], v[52:55], v[156:159], v[24:27]
    v_add_u32 v193, 256, v193
    s_waitcnt lgkmcnt(0)
    ds_read_b32 v195, v193 offset:64
    v_fma_f32 v36, v194, s83, -v29
    v_exp_f32 v36, v36
    s_nop 0
    v_cvt_pk_bf16_f32 v37, v36, v36
    v_add_f32 v30, v30, v36
    s_nop 0
    v_and_b32_dpp v40, v37, v16 row_newbcast:0 row_mask:0xf bank_mask:0xf
    v_and_b32_dpp v41, v37, v17 row_newbcast:0 row_mask:0xf bank_mask:0xf
    v_and_b32_dpp v42, v37, v18 row_newbcast:0 row_mask:0xf bank_mask:0xf
    v_and_b32_dpp v43, v37, v19 row_newbcast:0 row_mask:0xf bank_mask:0xf
    v_and_b32_dpp v44, v37, v16 row_newbcast:8 row_mask:0xf bank_mask:0xf
    v_and_b32_dpp v45, v37, v17 row_newbcast:8 row_mask:0xf bank_mask:0xf
    v_and_b32_dpp v46, v37, v18 row_newbcast:8 row_mask:0xf bank_mask:0xf
    v_and_b32_dpp v47, v37, v19 row_newbcast:8 row_mask:0xf bank_mask:0xf
    v_and_b32_dpp v48, v37, v16 row_newbcast:4 row_mask:0xf bank_mask:0xf
    v_and_b32_dpp v49, v37, v17 row_newbcast:4 row_mask:0xf bank_mask:0xf
    v_and_b32_dpp v50, v37, v18 row_newbcast:4 row_mask:0xf bank_mask:0xf
    v_and_b32_dpp v51, v37, v19 row_newbcast:4 row_mask:0xf bank_mask:0xf
    v_and_b32_dpp v52, v37, v16 row_newbcast:12 row_mask:0xf bank_mask:0xf
    v_and_b32_dpp v53, v37, v17 row_newbcast:12 row_mask:0xf bank_mask:0xf
    v_and_b32_dpp v54, v37, v18 row_newbcast:12 row_mask:0xf bank_mask:0xf
    v_and_b32_dpp v55, v37, v19 row_newbcast:12 row_mask:0xf bank_mask:0xf
    s_waitcnt vmcnt(12)
    v_mfma_f32_16x16x32_bf16 v[24:27], v[40:43], v[88:91], v[24:27]
    v_mfma_f32_16x16x32_bf16 v[24:27], v[44:47], v[92:95], v[24:27]
    v_mfma_f32_16x16x32_bf16 v[24:27], v[48:51], v[96:99], v[24:27]
    v_mfma_f32_16x16x32_bf16 v[24:27], v[52:55], v[100:103], v[24:27]
    s_branch L_dyn2x
L_got2x:
    s_cmp_ge_u32 s6, 2048
    s_cselect_b32 s90, 0x80000000, 0
    s_cselect_b32 s86, 1, 0
    v_or_b32 v38, s90, v9
    s_bfe_u32 s96, s6, 0x60000
    s_lshl_b32 s96, s96, 10
    s_bfe_u32 s97, s6, 0x10006
    s_lshl_b32 s97, s97, 19
    s_or_b32 s96, s96, s97
    s_bfe_u32 s97, s6, 0x10007
    s_lshl_b32 s97, s97, 18
    s_or_b32 s96, s96, s97
    s_bfe_u32 s97, s6, 0x30008
    s_lshl_b32 s97, s97, 20
    s_or_b32 s96, s96, s97
    s_add_u32 s96, s96, s84
    s_and_b32 s96, s96, 0x7fffff
    s_add_u32 s80, s96, s89
    s_mov_b32 s81, s80
    buffer_load_dwordx4 v[88:91], v38, s[8:11], s80 offen nt
    s_add_u32 s80, s80, 0x10000
    buffer_load_dwordx4 v[92:95], v38, s[8:11], s80 offen nt
    s_add_u32 s80, s80, 0x10000
    buffer_load_dwordx4 v[96:99], v38, s[8:11], s80 offen nt
    s_add_u32 s80, s80, 0x10000
    buffer_load_dwordx4 v[100:103], v38, s[8:11], s80 offen nt
    s_waitcnt lgkmcnt(0)
    ds_read_b32 v194, v193 offset:128
    v_fma_f32 v36, v195, s83, -v29
    v_exp_f32 v36, v36
    s_nop 0
    v_cvt_pk_bf16_f32 v37, v36, v36
    v_add_f32 v30, v30, v36
    s_nop 0
    v_and_b32_dpp v40, v37, v16 row_newbcast:0 row_mask:0xf bank_mask:0xf
    v_and_b32_dpp v41, v37, v17 row_newbcast:0 row_mask:0xf bank_mask:0xf
    v_and_b32_dpp v42, v37, v18 row_newbcast:0 row_mask:0xf bank_mask:0xf
    v_and_b32_dpp v43, v37, v19 row_newbcast:0 row_mask:0xf bank_mask:0xf
    v_and_b32_dpp v44, v37, v16 row_newbcast:8 row_mask:0xf bank_mask:0xf
    v_and_b32_dpp v45, v37, v17 row_newbcast:8 row_mask:0xf bank_mask:0xf
    v_and_b32_dpp v46, v37, v18 row_newbcast:8 row_mask:0xf bank_mask:0xf
    v_and_b32_dpp v47, v37, v19 row_newbcast:8 row_mask:0xf bank_mask:0xf
    v_and_b32_dpp v48, v37, v16 row_newbcast:4 row_mask:0xf bank_mask:0xf
    v_and_b32_dpp v49, v37, v17 row_newbcast:4 row_mask:0xf bank_mask:0xf
    v_and_b32_dpp v50, v37, v18 row_newbcast:4 row_mask:0xf bank_mask:0xf
    v_and_b32_dpp v51, v37, v19 row_newbcast:4 row_mask:0xf bank_mask:0xf
    v_and_b32_dpp v52, v37, v16 row_newbcast:12 row_mask:0xf bank_mask:0xf
    v_and_b32_dpp v53, v37, v17 row_newbcast:12 row_mask:0xf bank_mask:0xf
    v_and_b32_dpp v54, v37, v18 row_newbcast:12 row_mask:0xf bank_mask:0xf
    v_and_b32_dpp v55, v37, v19 row_newbcast:12 row_mask:0xf bank_mask:0xf
    s_waitcnt vmcnt(12)
    v_mfma_f32_16x16x32_bf16 v[24:27], v[40:43], v[160:163], v[24:27]
    v_mfma_f32_16x16x32_bf16 v[24:27], v[44:47], v[164:167], v[24:27]
    v_mfma_f32_16x16x32_bf16 v[24:27], v[48:51], v[168:171], v[24:27]
    v_mfma_f32_16x16x32_bf16 v[24:27], v[52:55], v[172:175], v[24:27]
    buffer_load_dwordx4 v[160:163], v38, s[12:15], s81 offen nt
    s_add_u32 s81, s81, 0x10000
    buffer_load_dwordx4 v[164:167], v38, s[12:15], s81 offen nt
    s_add_u32 s81, s81, 0x10000
    buffer_load_dwordx4 v[168:171], v38, s[12:15], s81 offen nt
    s_add_u32 s81, s81, 0x10000
    buffer_load_dwordx4 v[172:175], v38, s[12:15], s81 offen nt
    s_sub_u32 s87, s87, s86
    s_cbranch_scc1 L_loop_end
    s_waitcnt lgkmcnt(0)
    ds_read_b32 v195, v193 offset:192
    v_fma_f32 v36, v194, s83, -v29
    v_exp_f32 v36, v36
    s_nop 0
    v_cvt_pk_bf16_f32 v37, v36, v36
    v_add_f32 v30, v30, v36
    s_nop 0
    v_and_b32_dpp v40, v37, v16 row_newbcast:0 row_mask:0xf bank_mask:0xf
    v_and_b32_dpp v41, v37, v17 row_newbcast:0 row_mask:0xf bank_mask:0xf
    v_and_b32_dpp v42, v37, v18 row_newbcast:0 row_mask:0xf bank_mask:0xf
    v_and_b32_dpp v43, v37, v19 row_newbcast:0 row_mask:0xf bank_mask:0xf
    v_and_b32_dpp v44, v37, v16 row_newbcast:8 row_mask:0xf bank_mask:0xf
    v_and_b32_dpp v45, v37, v17 row_newbcast:8 row_mask:0xf bank_mask:0xf
    v_and_b32_dpp v46, v37, v18 row_newbcast:8 row_mask:0xf bank_mask:0xf
    v_and_b32_dpp v47, v37, v19 row_newbcast:8 row_mask:0xf bank_mask:0xf
    v_and_b32_dpp v48, v37, v16 row_newbcast:4 row_mask:0xf bank_mask:0xf
    v_and_b32_dpp v49, v37, v17 row_newbcast:4 row_mask:0xf bank_mask:0xf
    v_and_b32_dpp v50, v37, v18 row_newbcast:4 row_mask:0xf bank_mask:0xf
    v_and_b32_dpp v51, v37, v19 row_newbcast:4 row_mask:0xf bank_mask:0xf
    v_and_b32_dpp v52, v37, v16 row_newbcast:12 row_mask:0xf bank_mask:0xf
    v_and_b32_dpp v53, v37, v17 row_newbcast:12 row_mask:0xf bank_mask:0xf
    v_and_b32_dpp v54, v37, v18 row_newbcast:12 row_mask:0xf bank_mask:0xf
    v_and_b32_dpp v55, v37, v19 row_newbcast:12 row_mask:0xf bank_mask:0xf
    s_waitcnt vmcnt(12)
    v_mfma_f32_16x16x32_bf16 v[24:27], v[40:43], v[104:107], v[24:27]
    v_mfma_f32_16x16x32_bf16 v[24:27], v[44:47], v[108:111], v[24:27]
    v_mfma_f32_16x16x32_bf16 v[24:27], v[48:51], v[112:115], v[24:27]
    v_mfma_f32_16x16x32_bf16 v[24:27], v[52:55], v[116:119], v[24:27]
    s_branch L_dyn3x
L_got3x:
    s_cmp_ge_u32 s6, 2048
    s_cselect_b32 s90, 0x80000000, 0
    s_cselect_b32 s86, 1, 0
    v_or_b32 v38, s90, v9
    s_bfe_u32 s96, s6, 0x60000
    s_lshl_b32 s96, s96, 10
    s_bfe_u32 s97, s6, 0x10006
    s_lshl_b32 s97, s97, 19
    s_or_b32 s96, s96, s97
    s_bfe_u32 s97, s6, 0x10007
    s_lshl_b32 s97, s97, 18
    s_or_b32 s96, s96, s97
    s_bfe_u32 s97, s6, 0x30008
    s_lshl_b32 s97, s97, 20
    s_or_b32 s96, s96, s97
    s_add_u32 s96, s96, s84
    s_and_b32 s96, s96, 0x7fffff
    s_add_u32 s80, s96, s89
    s_mov_b32 s81, s80
    buffer_load_dwordx4 v[104:107], v38, s[8:11], s80 offen nt
    s_add_u32 s80, s80, 0x10000
    buffer_load_dwordx4 v[108:111], v38, s[8:11], s80 offen nt
    s_add_u32 s80, s80, 0x10000
    buffer_load_dwordx4 v[112:115], v38, s[8:11], s80 offen nt
    s_add_u32 s80, s80, 0x10000
    buffer_load_dwordx4 v[116:119], v38, s[8:11], s80 offen nt
    s_waitcnt lgkmcnt(0)
    ds_read_b32 v194, v193 offset:256
    v_fma_f32 v36, v195, s83, -v29
    v_exp_f32 v36, v36
    s_nop 0
    v_cvt_pk_bf16_f32 v37, v36, v36
    v_add_f32 v30, v30, v36
    s_nop 0
    v_and_b32_dpp v40, v37, v16 row_newbcast:0 row_mask:0xf bank_mask:0xf
    v_and_b32_dpp v41, v37, v17 row_newbcast:0 row_mask:0xf bank_mask:0xf
    v_and_b32_dpp v42, v37, v18 row_newbcast:0 row_mask:0xf bank_mask:0xf
    v_and_b32_dpp v43, v37, v19 row_newbcast:0 row_mask:0xf bank_mask:0xf
    v_and_b32_dpp v44, v37, v16 row_newbcast:8 row_mask:0xf bank_mask:0xf
    v_and_b32_dpp v45, v37, v17 row_newbcast:8 row_mask:0xf bank_mask:0xf
    v_and_b32_dpp v46, v37, v18 row_newbcast:8 row_mask:0xf bank_mask:0xf
    v_and_b32_dpp v47, v37, v19 row_newbcast:8 row_mask:0xf bank_mask:0xf
    v_and_b32_dpp v48, v37, v16 row_newbcast:4 row_mask:0xf bank_mask:0xf
    v_and_b32_dpp v49, v37, v17 row_newbcast:4 row_mask:0xf bank_mask:0xf
    v_and_b32_dpp v50, v37, v18 row_newbcast:4 row_mask:0xf bank_mask:0xf
    v_and_b32_dpp v51, v37, v19 row_newbcast:4 row_mask:0xf bank_mask:0xf
    v_and_b32_dpp v52, v37, v16 row_newbcast:12 row_mask:0xf bank_mask:0xf
    v_and_b32_dpp v53, v37, v17 row_newbcast:12 row_mask:0xf bank_mask:0xf
    v_and_b32_dpp v54, v37, v18 row_newbcast:12 row_mask:0xf bank_mask:0xf
    v_and_b32_dpp v55, v37, v19 row_newbcast:12 row_mask:0xf bank_mask:0xf
    s_waitcnt vmcnt(12)
    v_mfma_f32_16x16x32_bf16 v[24:27], v[40:43], v[176:179], v[24:27]
    v_mfma_f32_16x16x32_bf16 v[24:27], v[44:47], v[180:183], v[24:27]
    v_mfma_f32_16x16x32_bf16 v[24:27], v[48:51], v[184:187], v[24:27]
    v_mfma_f32_16x16x32_bf16 v[24:27], v[52:55], v[188:191], v[24:27]
    buffer_load_dwordx4 v[176:179], v38, s[12:15], s81 offen nt
    s_add_u32 s81, s81, 0x10000
    buffer_load_dwordx4 v[180:183], v38, s[12:15], s81 offen nt
    s_add_u32 s81, s81, 0x10000
    buffer_load_dwordx4 v[184:187], v38, s[12:15], s81 offen nt
    s_add_u32 s81, s81, 0x10000
    buffer_load_dwordx4 v[188:191], v38, s[12:15], s81 offen nt
    v_add_u32 v193, 256, v193
    s_sub_u32 s87, s87, s86
    s_cbranch_scc1 L_loop_end
    s_add_u32 s88, s88, 1
L_loop:
    s_branch L_dyn2
L_got2:
    s_cmp_ge_u32 s6, 2048
    s_cselect_b32 s90, 0x80000000, 0
    s_cselect_b32 s86, 1, 0
    v_or_b32 v38, s90, v9
    s_bfe_u32 s96, s6, 0x60000
    s_lshl_b32 s96, s96, 10
    s_bfe_u32 s97, s6, 0x10006
    s_lshl_b32 s97, s97, 19
    s_or_b32 s96, s96, s97
    s_bfe_u32 s97, s6, 0x10007
    s_lshl_b32 s97, s97, 18
    s_or_b32 s96, s96, s97
    s_bfe_u32 s97, s6, 0x30008
    s_lshl_b32 s97, s97, 20
    s_or_b32 s96, s96, s97
    s_add_u32 s96, s96, s84
    s_and_b32 s96, s96, 0x7fffff
    s_add_u32 s80, s96, s89
    s_mov_b32 s81, s80
    s_waitcnt vmcnt(12)
    v_dot2_f32_bf16 v32, v88, v20, 0
    v_dot2_f32_bf16 v33, v92, v20, 0
    v_dot2_f32_bf16 v34, v96, v20, 0
    v_dot2_f32_bf16 v35, v100, v20, 0
    v_dot2_f32_bf16 v32, v89, v21, v32
    v_dot2_f32_bf16 v33, v93, v21, v33
    v_dot2_f32_bf16 v34, v97, v21, v34
    v_dot2_f32_bf16 v35, v101, v21, v35
    v_dot2_f32_bf16 v32, v90, v22, v32
    v_dot2_f32_bf16 v33, v94, v22, v33
    v_dot2_f32_bf16 v34, v98, v22, v34
    v_dot2_f32_bf16 v35, v102, v22, v35
    v_dot2_f32_bf16 v32, v91, v23, v32
    v_dot2_f32_bf16 v33, v95, v23, v33
    v_dot2_f32_bf16 v34, v99, v23, v34
    v_dot2_f32_bf16 v35, v103, v23, v35
    buffer_load_dwordx4 v[88:91], v38, s[8:11], s80 offen nt
    s_add_u32 s80, s80, 0x10000
    buffer_load_dwordx4 v[92:95], v38, s[8:11], s80 offen nt
    s_add_u32 s80, s80, 0x10000
    buffer_load_dwordx4 v[96:99], v38, s[8:11], s80 offen nt
    s_add_u32 s80, s80, 0x10000
    v_add_f32_dpp v32, v32, v32 row_ror:8 row_mask:0xf bank_mask:0x3
    v_add_f32_dpp v32, v33, v33 row_ror:8 row_mask:0xf bank_mask:0xc
    v_add_f32_dpp v34, v34, v34 row_ror:8 row_mask:0xf bank_mask:0x3
    v_add_f32_dpp v34, v35, v35 row_ror:8 row_mask:0xf bank_mask:0xc
    buffer_load_dwordx4 v[100:103], v38, s[8:11], s80 offen nt
    v_add_f32_dpp v33, v32, v32 row_half_mirror row_mask:0xf bank_mask:0x5
    v_add_f32_dpp v33, v34, v34 row_half_mirror row_mask:0xf bank_mask:0xa
    s_nop 0
    s_nop 0
    v_add_f32_dpp v33, v33, v33 quad_perm:[1,0,3,2] row_mask:0xf bank_mask:0xf
    s_nop 1
    v_add_f32_dpp v33, v33, v33 quad_perm:[2,3,0,1] row_mask:0xf bank_mask:0xf
    s_nop 0
    v_cmp_gt_f32 vcc, v33, v28
    v_fma_f32 v36, v33, s83, -v29
    s_cbranch_vccnz L_resc_2
L_back_2:
    v_exp_f32 v36, v36
    s_nop 0
    v_cvt_pk_bf16_f32 v37, v36, v36
    v_add_f32 v30, v30, v36
    s_nop 0
    v_and_b32_dpp v40, v37, v16 row_newbcast:0 row_mask:0xf bank_mask:0xf
    v_and_b32_dpp v41, v37, v17 row_newbcast:0 row_mask:0xf bank_mask:0xf
    v_and_b32_dpp v42, v37, v18 row_newbcast:0 row_mask:0xf bank_mask:0xf
    v_and_b32_dpp v43, v37, v19 row_newbcast:0 row_mask:0xf bank_mask:0xf
    v_and_b32_dpp v44, v37, v16 row_newbcast:8 row_mask:0xf bank_mask:0xf
    v_and_b32_dpp v45, v37, v17 row_newbcast:8 row_mask:0xf bank_mask:0xf
    v_and_b32_dpp v46, v37, v18 row_newbcast:8 row_mask:0xf bank_mask:0xf
    v_and_b32_dpp v47, v37, v19 row_newbcast:8 row_mask:0xf bank_mask:0xf
    v_and_b32_dpp v48, v37, v16 row_newbcast:4 row_mask:0xf bank_mask:0xf
    v_and_b32_dpp v49, v37, v17 row_newbcast:4 row_mask:0xf bank_mask:0xf
    v_and_b32_dpp v50, v37, v18 row_newbcast:4 row_mask:0xf bank_mask:0xf
    v_and_b32_dpp v51, v37, v19 row_newbcast:4 row_mask:0xf bank_mask:0xf
    v_and_b32_dpp v52, v37, v16 row_newbcast:12 row_mask:0xf bank_mask:0xf
    v_and_b32_dpp v53, v37, v17 row_newbcast:12 row_mask:0xf bank_mask:0xf
    v_and_b32_dpp v54, v37, v18 row_newbcast:12 row_mask:0xf bank_mask:0xf
    v_and_b32_dpp v55, v37, v19 row_newbcast:12 row_mask:0xf bank_mask:0xf
    s_waitcnt vmcnt(12)
    v_mfma_f32_16x16x32_bf16 v[24:27], v[40:43], v[160:163], v[24:27]
    v_mfma_f32_16x16x32_bf16 v[24:27], v[44:47], v[164:167], v[24:27]
    v_mfma_f32_16x16x32_bf16 v[24:27], v[48:51], v[168:171], v[24:27]
    v_mfma_f32_16x16x32_bf16 v[24:27], v[52:55], v[172:175], v[24:27]
    buffer_load_dwordx4 v[160:163], v38, s[12:15], s81 offen nt
    s_add_u32 s81, s81, 0x10000
    buffer_load_dwordx4 v[164:167], v38, s[12:15], s81 offen nt
    s_add_u32 s81, s81, 0x10000
    buffer_load_dwordx4 v[168:171], v38, s[12:15], s81 offen nt
    s_add_u32 s81, s81, 0x10000
    buffer_load_dwordx4 v[172:175], v38, s[12:15], s81 offen nt
    s_sub_u32 s87, s87, s86
    s_cbranch_scc1 L_loop_end
    s_branch L_dyn3
L_got3:
    s_cmp_ge_u32 s6, 2048
    s_cselect_b32 s90, 0x80000000, 0
    s_cselect_b32 s86, 1, 0
    v_or_b32 v38, s90, v9
    s_bfe_u32 s96, s6, 0x60000
    s_lshl_b32 s96, s96, 10
    s_bfe_u32 s97, s6, 0x10006
    s_lshl_b32 s97, s97, 19
    s_or_b32 s96, s96, s97
    s_bfe_u32 s97, s6, 0x10007
    s_lshl_b32 s97, s97, 18
    s_or_b32 s96, s96, s97
    s_bfe_u32 s97, s6, 0x30008
    s_lshl_b32 s97, s97, 20
    s_or_b32 s96, s96, s97
    s_add_u32 s96, s96, s84
    s_and_b32 s96, s96, 0x7fffff
    s_add_u32 s80, s96, s89
    s_mov_b32 s81, s80
    s_waitcnt vmcnt(12)
    v_dot2_f32_bf16 v32, v104, v20, 0
    v_dot2_f32_bf16 v33, v108, v20, 0
    v_dot2_f32_bf16 v34, v112, v20, 0
    v_dot2_f32_bf16 v35, v116, v20, 0
    v_dot2_f32_bf16 v32, v105, v21, v32
    v_dot2_f32_bf16 v33, v109, v21, v33
    v_dot2_f32_bf16 v34, v113, v21, v34
    v_dot2_f32_bf16 v35, v117, v21, v35
    v_dot2_f32_bf16 v32, v106, v22, v32
    v_dot2_f32_bf16 v33, v110, v22, v33
    v_dot2_f32_bf16 v34, v114, v22, v34
    v_dot2_f32_bf16 v35, v118, v22, v35
    v_dot2_f32_bf16 v32, v107, v23, v32
    v_dot2_f32_bf16 v33, v111, v23, v33
    v_dot2_f32_bf16 v34, v115, v23, v34
    v_dot2_f32_bf16 v35, v119, v23, v35
    buffer_load_dwordx4 v[104:107], v38, s[8:11], s80 offen nt
    s_add_u32 s80, s80, 0x10000
    buffer_load_dwordx4 v[108:111], v38, s[8:11], s80 offen nt
    s_add_u32 s80, s80, 0x10000
    buffer_load_dwordx4 v[112:115], v38, s[8:11], s80 offen nt
    s_add_u32 s80, s80, 0x10000
    v_add_f32_dpp v32, v32, v32 row_ror:8 row_mask:0xf bank_mask:0x3
    v_add_f32_dpp v32, v33, v33 row_ror:8 row_mask:0xf bank_mask:0xc
    v_add_f32_dpp v34, v34, v34 row_ror:8 row_mask:0xf bank_mask:0x3
    v_add_f32_dpp v34, v35, v35 row_ror:8 row_mask:0xf bank_mask:0xc
    buffer_load_dwordx4 v[116:119], v38, s[8:11], s80 offen nt
    v_add_f32_dpp v33, v32, v32 row_half_mirror row_mask:0xf bank_mask:0x5
    v_add_f32_dpp v33, v34, v34 row_half_mirror row_mask:0xf bank_mask:0xa
    s_nop 0
    s_nop 0
    v_add_f32_dpp v33, v33, v33 quad_perm:[1,0,3,2] row_mask:0xf bank_mask:0xf
    s_nop 1
    v_add_f32_dpp v33, v33, v33 quad_perm:[2,3,0,1] row_mask:0xf bank_mask:0xf
    s_nop 0
    v_cmp_gt_f32 vcc, v33, v28
    v_fma_f32 v36, v33, s83, -v29
    s_cbranch_vccnz L_resc_3
L_back_3:
    v_exp_f32 v36, v36
    s_nop 0
    v_cvt_pk_bf16_f32 v37, v36, v36
    v_add_f32 v30, v30, v36
    s_nop 0
    v_and_b32_dpp v40, v37, v16 row_newbcast:0 row_mask:0xf bank_mask:0xf
    v_and_b32_dpp v41, v37, v17 row_newbcast:0 row_mask:0xf bank_mask:0xf
    v_and_b32_dpp v42, v37, v18 row_newbcast:0 row_mask:0xf bank_mask:0xf
    v_and_b32_dpp v43, v37, v19 row_newbcast:0 row_mask:0xf bank_mask:0xf
    v_and_b32_dpp v44, v37, v16 row_newbcast:8 row_mask:0xf bank_mask:0xf
    v_and_b32_dpp v45, v37, v17 row_newbcast:8 row_mask:0xf bank_mask:0xf
    v_and_b32_dpp v46, v37, v18 row_newbcast:8 row_mask:0xf bank_mask:0xf
    v_and_b32_dpp v47, v37, v19 row_newbcast:8 row_mask:0xf bank_mask:0xf
    v_and_b32_dpp v48, v37, v16 row_newbcast:4 row_mask:0xf bank_mask:0xf
    v_and_b32_dpp v49, v37, v17 row_newbcast:4 row_mask:0xf bank_mask:0xf
    v_and_b32_dpp v50, v37, v18 row_newbcast:4 row_mask:0xf bank_mask:0xf
    v_and_b32_dpp v51, v37, v19 row_newbcast:4 row_mask:0xf bank_mask:0xf
    v_and_b32_dpp v52, v37, v16 row_newbcast:12 row_mask:0xf bank_mask:0xf
    v_and_b32_dpp v53, v37, v17 row_newbcast:12 row_mask:0xf bank_mask:0xf
    v_and_b32_dpp v54, v37, v18 row_newbcast:12 row_mask:0xf bank_mask:0xf
    v_and_b32_dpp v55, v37, v19 row_newbcast:12 row_mask:0xf bank_mask:0xf
    s_waitcnt vmcnt(12)
    v_mfma_f32_16x16x32_bf16 v[24:27], v[40:43], v[176:179], v[24:27]
    v_mfma_f32_16x16x32_bf16 v[24:27], v[44:47], v[180:183], v[24:27]
    v_mfma_f32_16x16x32_bf16 v[24:27], v[48:51], v[184:187], v[24:27]
    v_mfma_f32_16x16x32_bf16 v[24:27], v[52:55], v[188:191], v[24:27]
    buffer_load_dwordx4 v[176:179], v38, s[12:15], s81 offen nt
    s_add_u32 s81, s81, 0x10000
    buffer_load_dwordx4 v[180:183], v38, s[12:15], s81 offen nt
    s_add_u32 s81, s81, 0x10000
    buffer_load_dwordx4 v[184:187], v38, s[12:15], s81 offen nt
    s_add_u32 s81, s81, 0x10000
    buffer_load_dwordx4 v[188:191], v38, s[12:15], s81 offen nt
    s_sub_u32 s87, s87, s86
    s_cbranch_scc1 L_loop_end
    s_add_u32 s88, s88, 1
    s_branch L_loop
L_loop_end:
    v_add_f32_dpp v30, v30, v30 row_ror:4 row_mask:0xf bank_mask:0xf
    s_nop 1
    v_add_f32_dpp v30, v30, v30 row_ror:8 row_mask:0xf bank_mask:0xf
    s_nop 1
    v_add_f32_dpp v30, v30, v30 row_bcast:15 row_mask:0xa bank_mask:0xf
    s_nop 1
    v_add_f32_dpp v30, v30, v30 row_bcast:31 row_mask:0xc bank_mask:0xf
    s_lshl_b32 s6, s76, 9
    v_lshlrev_b32 v3, 5, v12
    v_lshl_add_u32 v3, v11, 4, v3
    v_add_u32 v3, s6, v3
    s_lshl_b32 s7, s76, 3
    v_mov_b32 v6, s7
    v_mov_b32 v4, v29
    v_mov_b32 v5, v30
    s_mov_b32 exec_hi, 0
    ds_write_b128 v3, v[24:27] offset:512
    s_mov_b32 exec_lo, 0
    s_mov_b32 exec_hi, 0x80000000
    ds_write_b64 v6, v[4:5] offset:2560
    s_mov_b64 exec, -1
    s_waitcnt lgkmcnt(0)
    s_barrier
    s_and_b32 s6, s77, 7
    s_cmp_eq_u32 s6, s78
    s_cbranch_scc0 L_exit
    s_mov_b32 s46, 0x400
    s_mov_b32 s47, 0x20000
    s_mov_b32 s26, 0x400
    s_mov_b32 s27, 0x20000
    s_mov_b32 s44, s70
    s_and_b32 s45, s71, 0xffff
    s_mov_b32 s24, s52
    s_and_b32 s25, s53, 0xffff
    s_lshl_b32 s6, s77, 14
    s_lshl_b32 s7, s76, 12
    s_add_u32 s6, s6, s7
    v_add_u32 v4, s6, v2
    s_lshl_b32 s6, s77, 5
    v_lshl_add_u32 v7, v12, 1, s6
    buffer_load_ushort v10, v7, s[24:27], 0 offen
    v_and_b32 v3, 3, v12
    v_lshlrev_b32 v3, 4, v3
    v_lshl_add_u32 v3, v11, 2, v3
    s_lshl_b32 s6, s76, 6
    v_add_u32 v8, s6, v3
    v_lshlrev_b32 v9, 2, v12
    ds_read_b32 v13, v9 offset:2592
    s_mov_b32 s82, 8192
L_poll:
    buffer_load_dwordx4 v[56:59], v4, s[40:43], 0 offen offset:0 sc1
    buffer_load_dwordx4 v[60:63], v4, s[40:43], 0 offen offset:1024 sc1
    buffer_load_dwordx4 v[64:67], v4, s[40:43], 0 offen offset:2048 sc1
    buffer_load_dwordx4 v[68:71], v4, s[40:43], 0 offen offset:3072 sc1
    s_waitcnt vmcnt(0)
    v_bitop3_b32 v14, v56, v57, s92 bitop3:0x7e
    v_bitop3_b32 v14, v14, v58, s92 bitop3:0xf6
    v_bitop3_b32 v14, v14, v59, s92 bitop3:0xf6
    v_bitop3_b32 v14, v14, v60, s92 bitop3:0xf6
    v_bitop3_b32 v14, v14, v61, s92 bitop3:0xf6
    v_bitop3_b32 v14, v14, v62, s92 bitop3:0xf6
    v_bitop3_b32 v14, v14, v63, s92 bitop3:0xf6
    v_bitop3_b32 v14, v14, v64, s92 bitop3:0xf6
    v_bitop3_b32 v14, v14, v65, s92 bitop3:0xf6
    v_bitop3_b32 v14, v14, v66, s92 bitop3:0xf6
    v_bitop3_b32 v14, v14, v67, s92 bitop3:0xf6
    v_bitop3_b32 v14, v14, v68, s92 bitop3:0xf6
    v_bitop3_b32 v14, v14, v69, s92 bitop3:0xf6
    v_bitop3_b32 v14, v14, v70, s92 bitop3:0xf6
    v_bitop3_b32 v14, v14, v71, s92 bitop3:0xf6
    v_and_b32 v14, 0xff, v14
    v_cmp_ne_u32 vcc, 0, v14
    s_cbranch_vccz L_poll_ok
    s_sub_u32 s82, s82, 1
    s_cmp_lg_u32 s82, 0
    s_cbranch_scc1 L_poll
L_poll_ok:
    v_add_f32 v56, v56, v60
    v_add_f32 v64, v64, v68
    v_add_f32 v57, v57, v61
    v_add_f32 v65, v65, v69
    v_add_f32 v58, v58, v62
    v_add_f32 v66, v66, v70
    v_add_f32 v59, v59, v63
    v_add_f32 v67, v67, v71
    v_add_f32 v40, v56, v64
    v_add_f32 v41, v57, v65
    v_add_f32 v42, v58, v66
    v_add_f32 v43, v59, v67
    s_nop 0
    v_add_f32_dpp v40, v40, v40 row_ror:4 row_mask:0xf bank_mask:0xf
    v_add_f32_dpp v41, v41, v41 row_ror:4 row_mask:0xf bank_mask:0xf
    v_add_f32_dpp v42, v42, v42 row_ror:4 row_mask:0xf bank_mask:0xf
    v_add_f32_dpp v43, v43, v43 row_ror:4 row_mask:0xf bank_mask:0xf
    v_add_f32_dpp v40, v40, v40 row_ror:8 row_mask:0xf bank_mask:0xf
    v_add_f32_dpp v41, v41, v41 row_ror:8 row_mask:0xf bank_mask:0xf
    v_add_f32_dpp v42, v42, v42 row_ror:8 row_mask:0xf bank_mask:0xf
    v_add_f32_dpp v43, v43, v43 row_ror:8 row_mask:0xf bank_mask:0xf
    s_nop 0
    v_permlane32_swap_b32 v40, v42
    v_permlane32_swap_b32 v41, v43
    s_nop 0
    v_add_f32 v40, v40, v42
    v_add_f32 v41, v41, v43
    s_nop 1
    v_permlane16_swap_b32 v40, v41
    s_nop 0
    v_add_f32 v40, v40, v41
    s_mov_b32 exec_lo, 0x000f000f
    s_mov_b32 exec_hi, 0x000f000f
    ds_write_b32 v8, v40 offset:2688
    s_mov_b64 exec, -1
    v_lshlrev_b32 v10, 16, v10
    s_waitcnt lgkmcnt(0)
    s_barrier
    s_cmp_eq_u32 s76, 0
    s_cbranch_scc0 L_exit
    v_add_u32 v15, 2688, v9
    ds_read2_b32 v[48:49], v15 offset0:0 offset1:16
    ds_read2_b32 v[50:51], v15 offset0:32 offset1:48
    s_waitcnt lgkmcnt(0)
    v_add_f32 v48, v48, v49
    v_add_f32 v50, v50, v51
    v_add_f32 v48, v48, v50
    v_cvt_pk_bf16_f32 v48, v48, v48
    v_and_b32 v48, 0xffff0000, v48
    v_mul_f32 v48, v48, v13
    v_cvt_pk_bf16_f32 v48, v48, v48
    v_and_b32 v48, 0xffff0000, v48
    v_add_f32 v48, v10, v48
    v_cvt_pk_bf16_f32 v48, v48, v48
    s_mov_b64 exec, 0xffff
    buffer_store_short v48, v7, s[44:47], 0 offen
    s_mov_b64 exec, -1
    s_cmp_eq_u32 s77, 0
    s_cbranch_scc0 L_exit
    v_mov_b32 v3, 0xc0000
    v_mov_b32 v4, s91
    s_mov_b64 exec, 1
    buffer_store_dword v4, v3, s[40:43], 0 offen
    s_mov_b64 exec, -1
    s_branch L_exit
L_serv:
    s_mov_b32 s26, 0x400
    s_mov_b32 s27, 0x20000
    s_mov_b32 s42, 0x200000
    s_mov_b32 s43, 0x20000
    s_mov_b32 s22, 0x400000
    s_mov_b32 s23, 0x20000
    s_mov_b32 s30, 0x158000
    s_mov_b32 s31, 0x20000
    v_lshlrev_b32 v13, 4, v12
    v_lshl_add_u32 v78, v11, 10, v13
    s_lshl_b32 s6, s78, 5
    s_add_u32 s84, s6, s77
    s_sub_u32 s79, 224, s6
    s_add_u32 s79, s79, s77
    s_mov_b32 s93, 0xffffff00
    v_mov_b32 v10, 0x80000000
    s_cmp_eq_u32 s76, 0
    s_cbranch_scc1 L_set_q
    s_cmp_eq_u32 s76, 2
    s_cbranch_scc1 L_set_f
    s_waitcnt lgkmcnt(0)
    s_load_dword s91, s[74:75], 0xc0000
    s_mov_b32 s40, s74
    s_and_b32 s41, s75, 0xffff
    s_mov_b32 s20, s60
    s_and_b32 s21, s61, 0xffff
    s_mov_b32 s28, s68
    s_and_b32 s29, s69, 0xffff
    s_lshl_b32 s6, s2, 14
    s_lshl_b32 s7, s76, 8
    s_add_u32 s6, s6, s7
    buffer_load_dwordx4 v[192:195], v78, s[20:23], s6 offen nt
    s_add_u32 s6, s6, 0x1000
    buffer_load_dwordx4 v[196:199], v78, s[20:23], s6 offen nt
    s_add_u32 s6, s6, 0x1000
    buffer_load_dwordx4 v[200:203], v78, s[20:23], s6 offen nt
    s_add_u32 s6, s6, 0x1000
    buffer_load_dwordx4 v[204:207], v78, s[20:23], s6 offen nt
    s_cmp_lt_u32 s79, 86
    s_cbranch_scc0 L_pf_done0
    s_lshl_b32 s6, s79, 14
    s_add_u32 s6, s6, s7
    buffer_load_dwordx4 v[208:211], v78, s[28:31], s6 offen nt
    s_add_u32 s6, s6, 0x1000
    buffer_load_dwordx4 v[212:215], v78, s[28:31], s6 offen nt
    s_add_u32 s6, s6, 0x1000
    buffer_load_dwordx4 v[216:219], v78, s[28:31], s6 offen nt
    s_add_u32 s6, s6, 0x1000
    buffer_load_dwordx4 v[220:223], v78, s[28:31], s6 offen nt
L_pf_done0:
    s_mov_b64 s[96:97], s[74:75]
    s_lshl_b32 s3, s77, 10
    s_lshr_b32 s6, s76, 1
    s_lshl_b32 s7, s6, 9
    s_add_u32 s3, s3, s7
    s_add_u32 s3, s3, 0x100000
    v_lshrrev_b32 v3, 4, v1
    v_lshlrev_b32 v3, 7, v3
    v_lshl_add_u32 v3, v12, 2, v3
    v_add_u32 v3, s3, v3
    s_lshl_b32 s7, s6, 7
    v_lshl_add_u32 v4, v1, 1, s7
    s_mov_b32 s82, 8192
    s_waitcnt lgkmcnt(0)
    s_add_u32 s91, s91, 1
    s_and_b32 s92, s91, 0xff
    s_and_b32 s98, s91, 0xffff
L_sq:
    s_load_dwordx16 s[8:23], s[96:97], s3 offset:0 glc
    s_load_dwordx16 s[24:39], s[96:97], s3 offset:128 glc
    s_load_dwordx16 s[44:59], s[96:97], s3 offset:256 glc
    s_load_dwordx16 s[60:75], s[96:97], s3 offset:384 glc
    s_sub_u32 s82, s82, 1
    s_waitcnt lgkmcnt(0)
    s_xor_b32 s6, s23, s98
    s_xor_b32 s7, s39, s98
    s_or_b32 s6, s6, s7
    s_xor_b32 s7, s59, s98
    s_or_b32 s6, s6, s7
    s_xor_b32 s7, s75, s98
    s_or_b32 s6, s6, s7
    s_and_b32 s6, s6, 0xffff
    s_cbranch_scc0 L_sq_full
    s_cmp_gt_u32 s82, 8128
    s_cbranch_scc1 L_sq
    s_branch L_vq
L_sq_full:
    v_writelane_b32 v40, s8, 0
    v_writelane_b32 v40, s9, 1
    v_writelane_b32 v40, s10, 2
    v_writelane_b32 v40, s11, 3
    v_writelane_b32 v40, s12, 4
    v_writelane_b32 v40, s13, 5
    v_writelane_b32 v40, s14, 6
    v_writelane_b32 v40, s15, 7
    v_writelane_b32 v40, s16, 8
    v_writelane_b32 v40, s17, 9
    v_writelane_b32 v40, s18, 10
    v_writelane_b32 v40, s19, 11
    v_writelane_b32 v40, s20, 12
    v_writelane_b32 v40, s21, 13
    v_writelane_b32 v40, s22, 14
    v_writelane_b32 v40, s23, 15
    v_writelane_b32 v40, s24, 16
    v_writelane_b32 v40, s25, 17
    v_writelane_b32 v40, s26, 18
    v_writelane_b32 v40, s27, 19
    v_writelane_b32 v40, s28, 20
    v_writelane_b32 v40, s29, 21
    v_writelane_b32 v40, s30, 22
    v_writelane_b32 v40, s31, 23
    v_writelane_b32 v40, s32, 24
    v_writelane_b32 v40, s33, 25
    v_writelane_b32 v40, s34, 26
    v_writelane_b32 v40, s35, 27
    v_writelane_b32 v40, s36, 28
    v_writelane_b32 v40, s37, 29
    v_writelane_b32 v40, s38, 30
    v_writelane_b32 v40, s39, 31
    v_writelane_b32 v40, s44, 32
    v_writelane_b32 v40, s45, 33
    v_writelane_b32 v40, s46, 34
    v_writelane_b32 v40, s47, 35
    v_writelane_b32 v40, s48, 36
    v_writelane_b32 v40, s49, 37
    v_writelane_b32 v40, s50, 38
    v_writelane_b32 v40, s51, 39
    v_writelane_b32 v40, s52, 40
    v_writelane_b32 v40, s53, 41
    v_writelane_b32 v40, s54, 42
    v_writelane_b32 v40, s55, 43
    v_writelane_b32 v40, s56, 44
    v_writelane_b32 v40, s57, 45
    v_writelane_b32 v40, s58, 46
    v_writelane_b32 v40, s59, 47
    v_writelane_b32 v40, s60, 48
    v_writelane_b32 v40, s61, 49
    v_writelane_b32 v40, s62, 50
    v_writelane_b32 v40, s63, 51
    v_writelane_b32 v40, s64, 52
    v_writelane_b32 v40, s65, 53
    v_writelane_b32 v40, s66, 54
    v_writelane_b32 v40, s67, 55
    v_writelane_b32 v40, s68, 56
    v_writelane_b32 v40, s69, 57
    v_writelane_b32 v40, s70, 58
    v_writelane_b32 v40, s71, 59
    v_writelane_b32 v40, s72, 60
    v_writelane_b32 v40, s73, 61
    v_writelane_b32 v40, s74, 62
    v_writelane_b32 v40, s75, 63
    v_and_b32 v41, 0xffff, v40
    v_cmp_ne_u32 vcc, s98, v41
    s_cbranch_vccz L_q_ok
L_vq:
    buffer_load_dword v40, v3, s[40:43], 0 offen sc1
    s_waitcnt vmcnt(0)
    v_and_b32 v41, 0xffff, v40
    v_cmp_ne_u32 vcc, s98, v41
    s_cbranch_vccz L_q_ok
    s_sub_u32 s82, s82, 1
    s_cmp_lg_u32 s82, 0
    s_cbranch_scc1 L_vq
L_q_ok:
    ds_write_b16_d16_hi v4, v40 offset:0
    s_mov_b64 s[74:75], s[96:97]
    s_waitcnt lgkmcnt(0)
    s_barrier
    s_branch L_mid1
L_noq:
    s_waitcnt lgkmcnt(0)
    s_add_u32 s91, s91, 1
    s_and_b32 s92, s91, 0xff
    s_barrier
    s_branch L_mid1
L_set_q:
    s_mov_b32 s18, 0x400000
    s_mov_b32 s19, 0x20000
    s_lshl_b32 s85, s78, 2
    s_lshr_b32 s6, s49, 3
    s_add_u32 s85, s85, s6
    s_and_b32 s87, s49, 7
    v_lshrrev_b32 v3, 1, v1
    v_lshlrev_b32 v3, 17, v3
    v_and_b32 v4, 1, v1
    v_lshl_add_u32 v76, v4, 4, v3
    s_lshl_b32 s6, s85, 8
    s_lshl_b32 s7, s87, 5
    s_add_u32 s80, s6, s7
    v_lshlrev_b32 v4, 3, v4
    v_and_b32 v5, 1, v11
    v_lshl_add_u32 v4, v5, 2, v4
    v_bfe_u32 v5, v1, 2, 2
    v_add_u32 v4, v4, v5
    s_lshl_b32 s6, s85, 10
    s_lshl_b32 s7, s87, 7
    s_add_u32 s6, s6, s7
    s_add_u32 s6, s6, 0x100000
    v_lshl_add_u32 v4, v4, 2, s6
    v_and_b32 v5, 34, v1
    v_cmp_eq_u32 vcc, 0, v5
    s_lshl_b32 s6, s85, 12
    s_add_u32 s6, s6, 0x180000
    v_cndmask_b32 v77, v10, v4, vcc
    s_cmp_eq_u32 s87, 0
    s_cselect_b32 s6, s6, 0x80000000
    v_cmp_eq_u32 vcc, 0, v1
    v_mov_b32 v4, s6
    v_mov_b32 v9, 0
    v_cndmask_b32 v8, v10, v4, vcc
    s_waitcnt lgkmcnt(0)
    s_load_dword s91, s[74:75], 0xc0000
    s_mov_b32 s16, s58
    s_and_b32 s17, s59, 0xffff
    s_mov_b32 s24, s52
    s_and_b32 s25, s53, 0xffff
    s_mov_b32 s40, s74
    s_and_b32 s41, s75, 0xffff
    s_mov_b32 s20, s60
    s_and_b32 s21, s61, 0xffff
    s_mov_b32 s28, s68
    s_and_b32 s29, s69, 0xffff
    buffer_load_dwordx4 v[56:59], v2, s[24:27], 0 offen
    buffer_load_dwordx4 v[24:27], v76, s[16:19], s80 offen nt
    s_add_u32 s80, s80, 0x2000
    buffer_load_dwordx4 v[28:31], v76, s[16:19], s80 offen nt
    s_add_u32 s80, s80, 0x2000
    buffer_load_dwordx4 v[32:35], v76, s[16:19], s80 offen nt
    s_add_u32 s80, s80, 0x2000
    buffer_load_dwordx4 v[36:39], v76, s[16:19], s80 offen nt
    s_add_u32 s80, s80, 0x2000
    buffer_load_dwordx4 v[40:43], v76, s[16:19], s80 offen nt
    s_add_u32 s80, s80, 0x2000
    buffer_load_dwordx4 v[44:47], v76, s[16:19], s80 offen nt
    s_add_u32 s80, s80, 0x2000
    buffer_load_dwordx4 v[48:51], v76, s[16:19], s80 offen nt
    s_add_u32 s80, s80, 0x2000
    buffer_load_dwordx4 v[52:55], v76, s[16:19], s80 offen nt
    s_add_u32 s80, s80, 0x2000
    buffer_load_dwordx4 v[84:87], v76, s[16:19], s80 offen nt
    s_add_u32 s80, s80, 0x2000
    buffer_load_dwordx4 v[88:91], v76, s[16:19], s80 offen nt
    s_add_u32 s80, s80, 0x2000
    buffer_load_dwordx4 v[92:95], v76, s[16:19], s80 offen nt
    s_add_u32 s80, s80, 0x2000
    buffer_load_dwordx4 v[96:99], v76, s[16:19], s80 offen nt
    s_add_u32 s80, s80, 0x2000
    buffer_load_dwordx4 v[100:103], v76, s[16:19], s80 offen nt
    s_add_u32 s80, s80, 0x2000
    buffer_load_dwordx4 v[104:107], v76, s[16:19], s80 offen nt
    s_add_u32 s80, s80, 0x2000
    buffer_load_dwordx4 v[108:111], v76, s[16:19], s80 offen nt
    s_add_u32 s80, s80, 0x2000
    buffer_load_dwordx4 v[112:115], v76, s[16:19], s80 offen nt
    buffer_store_dword v9, v8, s[40:43], 0 offen sc1
    s_waitcnt vmcnt(17)
    v_lshlrev_b32 v60, 16, v56
    v_and_b32 v61, 0xffff0000, v56
    v_lshlrev_b32 v62, 16, v57
    v_and_b32 v63, 0xffff0000, v57
    v_lshlrev_b32 v64, 16, v58
    v_and_b32 v65, 0xffff0000, v58
    v_lshlrev_b32 v66, 16, v59
    v_and_b32 v67, 0xffff0000, v59
    v_add_f32 v3, v60, v61
    v_add_f32 v8, v62, v63
    v_add_f32 v9, v64, v65
    v_add_f32 v13, v66, v67
    v_add_f32 v3, v3, v8
    v_add_f32 v9, v9, v13
    v_add_f32 v3, v3, v9
    s_nop 1
    v_add_f32_dpp v3, v3, v3 row_ror:8 row_mask:0xf bank_mask:0xf
    s_nop 1
    v_add_f32_dpp v3, v3, v3 row_ror:4 row_mask:0xf bank_mask:0xf
    s_nop 1
    v_add_f32_dpp v3, v3, v3 row_ror:2 row_mask:0xf bank_mask:0xf
    s_nop 1
    v_add_f32_dpp v3, v3, v3 row_ror:1 row_mask:0xf bank_mask:0xf
    s_nop 0
    v_mov_b32 v8, v3
    s_nop 1
    v_permlane16_swap_b32 v3, v8
    s_nop 0
    v_add_f32 v3, v3, v8
    s_nop 0
    v_mov_b32 v8, v3
    s_nop 1
    v_permlane32_swap_b32 v3, v8
    s_nop 0
    v_add_f32 v3, v3, v8
    v_mul_f32 v3, 0x3b000000, v3
    v_sub_f32 v68, v60, v3
    v_sub_f32 v69, v61, v3
    v_sub_f32 v70, v62, v3
    v_sub_f32 v71, v63, v3
    v_sub_f32 v72, v64, v3
    v_sub_f32 v73, v65, v3
    v_sub_f32 v74, v66, v3
    v_sub_f32 v75, v67, v3
    v_mul_f32 v9, v68, v68
    v_fmac_f32 v9, v69, v69
    v_fmac_f32 v9, v70, v70
    v_fmac_f32 v9, v71, v71
    v_fmac_f32 v9, v72, v72
    v_fmac_f32 v9, v73, v73
    v_fmac_f32 v9, v74, v74
    v_fmac_f32 v9, v75, v75
    s_nop 1
    v_add_f32_dpp v9, v9, v9 row_ror:8 row_mask:0xf bank_mask:0xf
    s_nop 1
    v_add_f32_dpp v9, v9, v9 row_ror:4 row_mask:0xf bank_mask:0xf
    s_nop 1
    v_add_f32_dpp v9, v9, v9 row_ror:2 row_mask:0xf bank_mask:0xf
    s_nop 1
    v_add_f32_dpp v9, v9, v9 row_ror:1 row_mask:0xf bank_mask:0xf
    s_nop 0
    v_mov_b32 v8, v9
    s_nop 1
    v_permlane16_swap_b32 v9, v8
    s_nop 0
    v_add_f32 v9, v9, v8
    s_nop 0
    v_mov_b32 v8, v9
    s_nop 1
    v_permlane32_swap_b32 v9, v8
    s_nop 0
    v_add_f32 v9, v9, v8
    v_mul_f32 v9, 0x3b000000, v9
    v_cvt_pk_bf16_f32 v20, v3, v3
    v_and_b32 v20, 0xffff0000, v20
    v_cvt_pk_bf16_f32 v9, v9, v9
    v_and_b32 v9, 0xffff0000, v9
    v_add_f32 v9, 0x3727c5ac, v9
    v_cvt_pk_bf16_f32 v9, v9, v9
    v_and_b32 v9, 0xffff0000, v9
    v_sqrt_f32 v9, v9
    s_nop 0
    v_cvt_pk_bf16_f32 v21, v9, v9
    v_and_b32 v21, 0xffff0000, v21
    v_rcp_f32 v22, v21
    s_nop 0
    v_sub_f32 v60, v60, v20
    v_sub_f32 v61, v61, v20
    v_sub_f32 v62, v62, v20
    v_sub_f32 v63, v63, v20
    v_sub_f32 v64, v64, v20
    v_sub_f32 v65, v65, v20
    v_sub_f32 v66, v66, v20
    v_sub_f32 v67, v67, v20
    v_cvt_pk_bf16_f32 v56, v60, v61
    v_cvt_pk_bf16_f32 v57, v62, v63
    v_cvt_pk_bf16_f32 v58, v64, v65
    v_cvt_pk_bf16_f32 v59, v66, v67
    v_lshlrev_b32 v60, 16, v56
    v_and_b32 v61, 0xffff0000, v56
    v_lshlrev_b32 v62, 16, v57
    v_and_b32 v63, 0xffff0000, v57
    v_lshlrev_b32 v64, 16, v58
    v_and_b32 v65, 0xffff0000, v58
    v_lshlrev_b32 v66, 16, v59
    v_and_b32 v67, 0xffff0000, v59
    v_mul_f32 v68, v60, v22
    v_mul_f32 v69, v61, v22
    v_mul_f32 v70, v62, v22
    v_mul_f32 v71, v63, v22
    v_mul_f32 v72, v64, v22
    v_mul_f32 v73, v65, v22
    v_mul_f32 v74, v66, v22
    v_mul_f32 v75, v67, v22
    v_fma_f32 v60, -v68, v21, v60
    v_fma_f32 v61, -v69, v21, v61
    v_fma_f32 v62, -v70, v21, v62
    v_fma_f32 v63, -v71, v21, v63
    v_fma_f32 v64, -v72, v21, v64
    v_fma_f32 v65, -v73, v21, v65
    v_fma_f32 v66, -v74, v21, v66
    v_fma_f32 v67, -v75, v21, v67
    v_fmac_f32 v68, v60, v22
    v_fmac_f32 v69, v61, v22
    v_fmac_f32 v70, v62, v22
    v_fmac_f32 v71, v63, v22
    v_fmac_f32 v72, v64, v22
    v_fmac_f32 v73, v65, v22
    v_fmac_f32 v74, v66, v22
    v_fmac_f32 v75, v67, v22
    v_cvt_pk_bf16_f32 v56, v68, v69
    v_cvt_pk_bf16_f32 v57, v70, v71
    v_cvt_pk_bf16_f32 v58, v72, v73
    v_cvt_pk_bf16_f32 v59, v74, v75
    v_and_b32 v60, 0xffff, v56
    v_lshlrev_b32 v68, 16, v56
    v_lshrrev_b32 v61, 16, v56
    v_and_b32 v69, 0xffff0000, v56
    v_and_b32 v62, 0xffff, v57
    v_lshlrev_b32 v70, 16, v57
    v_lshrrev_b32 v63, 16, v57
    v_and_b32 v71, 0xffff0000, v57
    v_and_b32 v64, 0xffff, v58
    v_lshlrev_b32 v72, 16, v58
    v_lshrrev_b32 v65, 16, v58
    v_and_b32 v73, 0xffff0000, v58
    v_and_b32 v66, 0xffff, v59
    v_lshlrev_b32 v74, 16, v59
    v_lshrrev_b32 v67, 16, v59
    v_and_b32 v75, 0xffff0000, v59
    v_mov_b32 v116, 0
    v_mov_b32 v117, 0
    v_mov_b32 v118, 0
    v_mov_b32 v119, 0
    v_mov_b32 v79, 0
    v_mov_b32 v80, 0
    v_mov_b32 v81, 0
    v_mov_b32 v82, 0
    s_waitcnt vmcnt(15)
    v_dot2c_f32_bf16_dpp v116, v60, v24 quad_perm:[0,0,2,2] row_mask:0xf bank_mask:0xf
    v_dot2c_f32_bf16_dpp v117, v68, v24 quad_perm:[0,0,2,2] row_mask:0xf bank_mask:0xf
    v_dot2c_f32_bf16_dpp v118, v60, v25 quad_perm:[0,0,2,2] row_mask:0xf bank_mask:0xf
    v_dot2c_f32_bf16_dpp v119, v68, v25 quad_perm:[0,0,2,2] row_mask:0xf bank_mask:0xf
    v_dot2c_f32_bf16_dpp v79, v60, v26 quad_perm:[0,0,2,2] row_mask:0xf bank_mask:0xf
    v_dot2c_f32_bf16_dpp v80, v68, v26 quad_perm:[0,0,2,2] row_mask:0xf bank_mask:0xf
    v_dot2c_f32_bf16_dpp v81, v60, v27 quad_perm:[0,0,2,2] row_mask:0xf bank_mask:0xf
    v_dot2c_f32_bf16_dpp v82, v68, v27 quad_perm:[0,0,2,2] row_mask:0xf bank_mask:0xf
    v_dot2c_f32_bf16_dpp v116, v61, v28 quad_perm:[0,0,2,2] row_mask:0xf bank_mask:0xf
    v_dot2c_f32_bf16_dpp v117, v69, v28 quad_perm:[0,0,2,2] row_mask:0xf bank_mask:0xf
    v_dot2c_f32_bf16_dpp v118, v61, v29 quad_perm:[0,0,2,2] row_mask:0xf bank_mask:0xf
    v_dot2c_f32_bf16_dpp v119, v69, v29 quad_perm:[0,0,2,2] row_mask:0xf bank_mask:0xf
    v_dot2c_f32_bf16_dpp v79, v61, v30 quad_perm:[0,0,2,2] row_mask:0xf bank_mask:0xf
    v_dot2c_f32_bf16_dpp v80, v69, v30 quad_perm:[0,0,2,2] row_mask:0xf bank_mask:0xf
    v_dot2c_f32_bf16_dpp v81, v61, v31 quad_perm:[0,0,2,2] row_mask:0xf bank_mask:0xf
    v_dot2c_f32_bf16_dpp v82, v69, v31 quad_perm:[0,0,2,2] row_mask:0xf bank_mask:0xf
    s_waitcnt vmcnt(13)
    v_dot2c_f32_bf16_dpp v116, v62, v32 quad_perm:[0,0,2,2] row_mask:0xf bank_mask:0xf
    v_dot2c_f32_bf16_dpp v117, v70, v32 quad_perm:[0,0,2,2] row_mask:0xf bank_mask:0xf
    v_dot2c_f32_bf16_dpp v118, v62, v33 quad_perm:[0,0,2,2] row_mask:0xf bank_mask:0xf
    v_dot2c_f32_bf16_dpp v119, v70, v33 quad_perm:[0,0,2,2] row_mask:0xf bank_mask:0xf
    v_dot2c_f32_bf16_dpp v79, v62, v34 quad_perm:[0,0,2,2] row_mask:0xf bank_mask:0xf
    v_dot2c_f32_bf16_dpp v80, v70, v34 quad_perm:[0,0,2,2] row_mask:0xf bank_mask:0xf
    v_dot2c_f32_bf16_dpp v81, v62, v35 quad_perm:[0,0,2,2] row_mask:0xf bank_mask:0xf
    v_dot2c_f32_bf16_dpp v82, v70, v35 quad_perm:[0,0,2,2] row_mask:0xf bank_mask:0xf
    v_dot2c_f32_bf16_dpp v116, v63, v36 quad_perm:[0,0,2,2] row_mask:0xf bank_mask:0xf
    v_dot2c_f32_bf16_dpp v117, v71, v36 quad_perm:[0,0,2,2] row_mask:0xf bank_mask:0xf
    v_dot2c_f32_bf16_dpp v118, v63, v37 quad_perm:[0,0,2,2] row_mask:0xf bank_mask:0xf
    v_dot2c_f32_bf16_dpp v119, v71, v37 quad_perm:[0,0,2,2] row_mask:0xf bank_mask:0xf
    v_dot2c_f32_bf16_dpp v79, v63, v38 quad_perm:[0,0,2,2] row_mask:0xf bank_mask:0xf
    v_dot2c_f32_bf16_dpp v80, v71, v38 quad_perm:[0,0,2,2] row_mask:0xf bank_mask:0xf
    v_dot2c_f32_bf16_dpp v81, v63, v39 quad_perm:[0,0,2,2] row_mask:0xf bank_mask:0xf
    v_dot2c_f32_bf16_dpp v82, v71, v39 quad_perm:[0,0,2,2] row_mask:0xf bank_mask:0xf
    s_waitcnt vmcnt(11)
    v_dot2c_f32_bf16_dpp v116, v64, v40 quad_perm:[0,0,2,2] row_mask:0xf bank_mask:0xf
    v_dot2c_f32_bf16_dpp v117, v72, v40 quad_perm:[0,0,2,2] row_mask:0xf bank_mask:0xf
    v_dot2c_f32_bf16_dpp v118, v64, v41 quad_perm:[0,0,2,2] row_mask:0xf bank_mask:0xf
    v_dot2c_f32_bf16_dpp v119, v72, v41 quad_perm:[0,0,2,2] row_mask:0xf bank_mask:0xf
    v_dot2c_f32_bf16_dpp v79, v64, v42 quad_perm:[0,0,2,2] row_mask:0xf bank_mask:0xf
    v_dot2c_f32_bf16_dpp v80, v72, v42 quad_perm:[0,0,2,2] row_mask:0xf bank_mask:0xf
    v_dot2c_f32_bf16_dpp v81, v64, v43 quad_perm:[0,0,2,2] row_mask:0xf bank_mask:0xf
    v_dot2c_f32_bf16_dpp v82, v72, v43 quad_perm:[0,0,2,2] row_mask:0xf bank_mask:0xf
    v_dot2c_f32_bf16_dpp v116, v65, v44 quad_perm:[0,0,2,2] row_mask:0xf bank_mask:0xf
    v_dot2c_f32_bf16_dpp v117, v73, v44 quad_perm:[0,0,2,2] row_mask:0xf bank_mask:0xf
    v_dot2c_f32_bf16_dpp v118, v65, v45 quad_perm:[0,0,2,2] row_mask:0xf bank_mask:0xf
    v_dot2c_f32_bf16_dpp v119, v73, v45 quad_perm:[0,0,2,2] row_mask:0xf bank_mask:0xf
    v_dot2c_f32_bf16_dpp v79, v65, v46 quad_perm:[0,0,2,2] row_mask:0xf bank_mask:0xf
    v_dot2c_f32_bf16_dpp v80, v73, v46 quad_perm:[0,0,2,2] row_mask:0xf bank_mask:0xf
    v_dot2c_f32_bf16_dpp v81, v65, v47 quad_perm:[0,0,2,2] row_mask:0xf bank_mask:0xf
    v_dot2c_f32_bf16_dpp v82, v73, v47 quad_perm:[0,0,2,2] row_mask:0xf bank_mask:0xf
    s_waitcnt vmcnt(9)
    v_dot2c_f32_bf16_dpp v116, v66, v48 quad_perm:[0,0,2,2] row_mask:0xf bank_mask:0xf
    v_dot2c_f32_bf16_dpp v117, v74, v48 quad_perm:[0,0,2,2] row_mask:0xf bank_mask:0xf
    v_dot2c_f32_bf16_dpp v118, v66, v49 quad_perm:[0,0,2,2] row_mask:0xf bank_mask:0xf
    v_dot2c_f32_bf16_dpp v119, v74, v49 quad_perm:[0,0,2,2] row_mask:0xf bank_mask:0xf
    v_dot2c_f32_bf16_dpp v79, v66, v50 quad_perm:[0,0,2,2] row_mask:0xf bank_mask:0xf
    v_dot2c_f32_bf16_dpp v80, v74, v50 quad_perm:[0,0,2,2] row_mask:0xf bank_mask:0xf
    v_dot2c_f32_bf16_dpp v81, v66, v51 quad_perm:[0,0,2,2] row_mask:0xf bank_mask:0xf
    v_dot2c_f32_bf16_dpp v82, v74, v51 quad_perm:[0,0,2,2] row_mask:0xf bank_mask:0xf
    v_dot2c_f32_bf16_dpp v116, v67, v52 quad_perm:[0,0,2,2] row_mask:0xf bank_mask:0xf
    v_dot2c_f32_bf16_dpp v117, v75, v52 quad_perm:[0,0,2,2] row_mask:0xf bank_mask:0xf
    v_dot2c_f32_bf16_dpp v118, v67, v53 quad_perm:[0,0,2,2] row_mask:0xf bank_mask:0xf
    v_dot2c_f32_bf16_dpp v119, v75, v53 quad_perm:[0,0,2,2] row_mask:0xf bank_mask:0xf
    v_dot2c_f32_bf16_dpp v79, v67, v54 quad_perm:[0,0,2,2] row_mask:0xf bank_mask:0xf
    v_dot2c_f32_bf16_dpp v80, v75, v54 quad_perm:[0,0,2,2] row_mask:0xf bank_mask:0xf
    v_dot2c_f32_bf16_dpp v81, v67, v55 quad_perm:[0,0,2,2] row_mask:0xf bank_mask:0xf
    v_dot2c_f32_bf16_dpp v82, v75, v55 quad_perm:[0,0,2,2] row_mask:0xf bank_mask:0xf
    s_waitcnt vmcnt(7)
    v_dot2c_f32_bf16_dpp v116, v60, v84 quad_perm:[1,1,3,3] row_mask:0xf bank_mask:0xf
    v_dot2c_f32_bf16_dpp v117, v68, v84 quad_perm:[1,1,3,3] row_mask:0xf bank_mask:0xf
    v_dot2c_f32_bf16_dpp v118, v60, v85 quad_perm:[1,1,3,3] row_mask:0xf bank_mask:0xf
    v_dot2c_f32_bf16_dpp v119, v68, v85 quad_perm:[1,1,3,3] row_mask:0xf bank_mask:0xf
    v_dot2c_f32_bf16_dpp v79, v60, v86 quad_perm:[1,1,3,3] row_mask:0xf bank_mask:0xf
    v_dot2c_f32_bf16_dpp v80, v68, v86 quad_perm:[1,1,3,3] row_mask:0xf bank_mask:0xf
    v_dot2c_f32_bf16_dpp v81, v60, v87 quad_perm:[1,1,3,3] row_mask:0xf bank_mask:0xf
    v_dot2c_f32_bf16_dpp v82, v68, v87 quad_perm:[1,1,3,3] row_mask:0xf bank_mask:0xf
    v_dot2c_f32_bf16_dpp v116, v61, v88 quad_perm:[1,1,3,3] row_mask:0xf bank_mask:0xf
    v_dot2c_f32_bf16_dpp v117, v69, v88 quad_perm:[1,1,3,3] row_mask:0xf bank_mask:0xf
    v_dot2c_f32_bf16_dpp v118, v61, v89 quad_perm:[1,1,3,3] row_mask:0xf bank_mask:0xf
    v_dot2c_f32_bf16_dpp v119, v69, v89 quad_perm:[1,1,3,3] row_mask:0xf bank_mask:0xf
    v_dot2c_f32_bf16_dpp v79, v61, v90 quad_perm:[1,1,3,3] row_mask:0xf bank_mask:0xf
    v_dot2c_f32_bf16_dpp v80, v69, v90 quad_perm:[1,1,3,3] row_mask:0xf bank_mask:0xf
    v_dot2c_f32_bf16_dpp v81, v61, v91 quad_perm:[1,1,3,3] row_mask:0xf bank_mask:0xf
    v_dot2c_f32_bf16_dpp v82, v69, v91 quad_perm:[1,1,3,3] row_mask:0xf bank_mask:0xf
    s_waitcnt vmcnt(5)
    v_dot2c_f32_bf16_dpp v116, v62, v92 quad_perm:[1,1,3,3] row_mask:0xf bank_mask:0xf
    v_dot2c_f32_bf16_dpp v117, v70, v92 quad_perm:[1,1,3,3] row_mask:0xf bank_mask:0xf
    v_dot2c_f32_bf16_dpp v118, v62, v93 quad_perm:[1,1,3,3] row_mask:0xf bank_mask:0xf
    v_dot2c_f32_bf16_dpp v119, v70, v93 quad_perm:[1,1,3,3] row_mask:0xf bank_mask:0xf
    v_dot2c_f32_bf16_dpp v79, v62, v94 quad_perm:[1,1,3,3] row_mask:0xf bank_mask:0xf
    v_dot2c_f32_bf16_dpp v80, v70, v94 quad_perm:[1,1,3,3] row_mask:0xf bank_mask:0xf
    v_dot2c_f32_bf16_dpp v81, v62, v95 quad_perm:[1,1,3,3] row_mask:0xf bank_mask:0xf
    v_dot2c_f32_bf16_dpp v82, v70, v95 quad_perm:[1,1,3,3] row_mask:0xf bank_mask:0xf
    v_dot2c_f32_bf16_dpp v116, v63, v96 quad_perm:[1,1,3,3] row_mask:0xf bank_mask:0xf
    v_dot2c_f32_bf16_dpp v117, v71, v96 quad_perm:[1,1,3,3] row_mask:0xf bank_mask:0xf
    v_dot2c_f32_bf16_dpp v118, v63, v97 quad_perm:[1,1,3,3] row_mask:0xf bank_mask:0xf
    v_dot2c_f32_bf16_dpp v119, v71, v97 quad_perm:[1,1,3,3] row_mask:0xf bank_mask:0xf
    v_dot2c_f32_bf16_dpp v79, v63, v98 quad_perm:[1,1,3,3] row_mask:0xf bank_mask:0xf
    v_dot2c_f32_bf16_dpp v80, v71, v98 quad_perm:[1,1,3,3] row_mask:0xf bank_mask:0xf
    v_dot2c_f32_bf16_dpp v81, v63, v99 quad_perm:[1,1,3,3] row_mask:0xf bank_mask:0xf
    v_dot2c_f32_bf16_dpp v82, v71, v99 quad_perm:[1,1,3,3] row_mask:0xf bank_mask:0xf
    s_waitcnt vmcnt(3)
    v_dot2c_f32_bf16_dpp v116, v64, v100 quad_perm:[1,1,3,3] row_mask:0xf bank_mask:0xf
    v_dot2c_f32_bf16_dpp v117, v72, v100 quad_perm:[1,1,3,3] row_mask:0xf bank_mask:0xf
    v_dot2c_f32_bf16_dpp v118, v64, v101 quad_perm:[1,1,3,3] row_mask:0xf bank_mask:0xf
    v_dot2c_f32_bf16_dpp v119, v72, v101 quad_perm:[1,1,3,3] row_mask:0xf bank_mask:0xf
    v_dot2c_f32_bf16_dpp v79, v64, v102 quad_perm:[1,1,3,3] row_mask:0xf bank_mask:0xf
    v_dot2c_f32_bf16_dpp v80, v72, v102 quad_perm:[1,1,3,3] row_mask:0xf bank_mask:0xf
    v_dot2c_f32_bf16_dpp v81, v64, v103 quad_perm:[1,1,3,3] row_mask:0xf bank_mask:0xf
    v_dot2c_f32_bf16_dpp v82, v72, v103 quad_perm:[1,1,3,3] row_mask:0xf bank_mask:0xf
    v_dot2c_f32_bf16_dpp v116, v65, v104 quad_perm:[1,1,3,3] row_mask:0xf bank_mask:0xf
    v_dot2c_f32_bf16_dpp v117, v73, v104 quad_perm:[1,1,3,3] row_mask:0xf bank_mask:0xf
    v_dot2c_f32_bf16_dpp v118, v65, v105 quad_perm:[1,1,3,3] row_mask:0xf bank_mask:0xf
    v_dot2c_f32_bf16_dpp v119, v73, v105 quad_perm:[1,1,3,3] row_mask:0xf bank_mask:0xf
    v_dot2c_f32_bf16_dpp v79, v65, v106 quad_perm:[1,1,3,3] row_mask:0xf bank_mask:0xf
    v_dot2c_f32_bf16_dpp v80, v73, v106 quad_perm:[1,1,3,3] row_mask:0xf bank_mask:0xf
    v_dot2c_f32_bf16_dpp v81, v65, v107 quad_perm:[1,1,3,3] row_mask:0xf bank_mask:0xf
    v_dot2c_f32_bf16_dpp v82, v73, v107 quad_perm:[1,1,3,3] row_mask:0xf bank_mask:0xf
    s_waitcnt vmcnt(1)
    v_dot2c_f32_bf16_dpp v116, v66, v108 quad_perm:[1,1,3,3] row_mask:0xf bank_mask:0xf
    v_dot2c_f32_bf16_dpp v117, v74, v108 quad_perm:[1,1,3,3] row_mask:0xf bank_mask:0xf
    v_dot2c_f32_bf16_dpp v118, v66, v109 quad_perm:[1,1,3,3] row_mask:0xf bank_mask:0xf
    v_dot2c_f32_bf16_dpp v119, v74, v109 quad_perm:[1,1,3,3] row_mask:0xf bank_mask:0xf
    v_dot2c_f32_bf16_dpp v79, v66, v110 quad_perm:[1,1,3,3] row_mask:0xf bank_mask:0xf
    v_dot2c_f32_bf16_dpp v80, v74, v110 quad_perm:[1,1,3,3] row_mask:0xf bank_mask:0xf
    v_dot2c_f32_bf16_dpp v81, v66, v111 quad_perm:[1,1,3,3] row_mask:0xf bank_mask:0xf
    v_dot2c_f32_bf16_dpp v82, v74, v111 quad_perm:[1,1,3,3] row_mask:0xf bank_mask:0xf
    v_dot2c_f32_bf16_dpp v116, v67, v112 quad_perm:[1,1,3,3] row_mask:0xf bank_mask:0xf
    v_dot2c_f32_bf16_dpp v117, v75, v112 quad_perm:[1,1,3,3] row_mask:0xf bank_mask:0xf
    v_dot2c_f32_bf16_dpp v118, v67, v113 quad_perm:[1,1,3,3] row_mask:0xf bank_mask:0xf
    v_dot2c_f32_bf16_dpp v119, v75, v113 quad_perm:[1,1,3,3] row_mask:0xf bank_mask:0xf
    v_dot2c_f32_bf16_dpp v79, v67, v114 quad_perm:[1,1,3,3] row_mask:0xf bank_mask:0xf
    v_dot2c_f32_bf16_dpp v80, v75, v114 quad_perm:[1,1,3,3] row_mask:0xf bank_mask:0xf
    v_dot2c_f32_bf16_dpp v81, v67, v115 quad_perm:[1,1,3,3] row_mask:0xf bank_mask:0xf
    v_dot2c_f32_bf16_dpp v82, v75, v115 quad_perm:[1,1,3,3] row_mask:0xf bank_mask:0xf
    s_nop 2
    v_add_f32_dpp v116, v116, v116 row_ror:8 row_mask:0xf bank_mask:0x3
    v_add_f32_dpp v117, v117, v117 row_ror:8 row_mask:0xf bank_mask:0x3
    v_add_f32_dpp v79, v79, v79 row_ror:8 row_mask:0xf bank_mask:0x3
    v_add_f32_dpp v80, v80, v80 row_ror:8 row_mask:0xf bank_mask:0x3
    v_add_f32_dpp v116, v118, v118 row_ror:8 row_mask:0xf bank_mask:0xc
    v_add_f32_dpp v117, v119, v119 row_ror:8 row_mask:0xf bank_mask:0xc
    v_add_f32_dpp v79, v81, v81 row_ror:8 row_mask:0xf bank_mask:0xc
    v_add_f32_dpp v80, v82, v82 row_ror:8 row_mask:0xf bank_mask:0xc
    s_nop 0
    v_add_f32_dpp v116, v116, v116 row_shl:4 row_mask:0xf bank_mask:0x5
    v_add_f32_dpp v79, v79, v79 row_shl:4 row_mask:0xf bank_mask:0x5
    v_add_f32_dpp v116, v117, v117 row_shr:4 row_mask:0xf bank_mask:0xa
    v_add_f32_dpp v79, v80, v80 row_shr:4 row_mask:0xf bank_mask:0xa
    s_nop 1
    v_add_f32_dpp v116, v116, v116 quad_perm:[2,3,0,1] row_mask:0xf bank_mask:0xf
    v_add_f32_dpp v79, v79, v79 quad_perm:[2,3,0,1] row_mask:0xf bank_mask:0xf
    s_mov_b32 s7, 0xffff0000
    s_waitcnt lgkmcnt(0)
    s_add_u32 s91, s91, 1
    s_and_b32 s92, s91, 0xff
    v_permlane16_swap_b32 v116, v79
    s_and_b32 s98, s91, 0xffff
    v_mov_b32 v14, s92
    v_add_f32 v116, v116, v79
    v_mov_b32 v4, s98
    v_mov_b32 v79, v116
    s_nop 1
    v_permlane32_swap_b32 v116, v79
    s_nop 0
    v_add_f32 v116, v116, v79
    v_cvt_pk_bf16_f32 v116, v116, v116
    v_and_or_b32 v116, v116, s7, v4
    s_waitcnt vmcnt(0)
    buffer_store_dword v116, v77, s[40:43], 0 offen sc1
    s_lshl_b32 s6, s2, 14
    s_lshl_b32 s7, s76, 8
    s_add_u32 s6, s6, s7
    buffer_load_dwordx4 v[192:195], v78, s[20:23], s6 offen nt
    s_add_u32 s6, s6, 0x1000
    buffer_load_dwordx4 v[196:199], v78, s[20:23], s6 offen nt
    s_add_u32 s6, s6, 0x1000
    buffer_load_dwordx4 v[200:203], v78, s[20:23], s6 offen nt
    s_add_u32 s6, s6, 0x1000
    buffer_load_dwordx4 v[204:207], v78, s[20:23], s6 offen nt
    s_cmp_lt_u32 s79, 86
    s_cbranch_scc0 L_pf_done1
    s_lshl_b32 s6, s79, 14
    s_add_u32 s6, s6, s7
    buffer_load_dwordx4 v[208:211], v78, s[28:31], s6 offen nt
    s_add_u32 s6, s6, 0x1000
    buffer_load_dwordx4 v[212:215], v78, s[28:31], s6 offen nt
    s_add_u32 s6, s6, 0x1000
    buffer_load_dwordx4 v[216:219], v78, s[28:31], s6 offen nt
    s_add_u32 s6, s6, 0x1000
    buffer_load_dwordx4 v[220:223], v78, s[28:31], s6 offen nt
L_pf_done1:
    s_barrier
    s_branch L_mid
L_set_f:
    s_mov_b32 s18, 0x158000
    s_mov_b32 s19, 0x20000
    v_mul_u32_u24 v76, 2752, v11
    v_add_u32 v76, v76, v13
    s_and_b32 s6, s84, 7
    s_lshr_b32 s7, s84, 4
    s_mul_i32 s80, s6, 176128
    s_lshl_b32 s3, s7, 8
    s_add_u32 s80, s80, s3
    s_mov_b32 s87, 11008
    s_lshl_b32 s3, s6, 7
    v_lshlrev_b32 v3, 3, v12
    v_lshl_add_u32 v3, v11, 1, v3
    v_add_u32 v83, s3, v3
    s_and_b32 s3, s84, 15
    s_lshl_b32 s3, s3, 6
    s_lshl_b32 s7, s7, 13
    s_add_u32 s3, s3, s7
    s_add_u32 s3, s3, 0x120000
    v_cmp_gt_u32 vcc, 32, v1
    v_lshrrev_b32 v4, 1, v12
    v_lshlrev_b32 v4, 10, v4
    v_and_b32 v5, 1, v12
    v_lshl_add_u32 v4, v5, 5, v4
    v_lshl_add_u32 v4, v11, 4, v4
    v_add_u32 v4, s3, v4
    v_cndmask_b32 v77, v10, v4, vcc
    s_waitcnt lgkmcnt(0)
    s_load_dword s91, s[74:75], 0xc0000
    s_bitcmp1_b32 s84, 3
    s_cselect_b32 s16, s66, s64
    s_cselect_b32 s17, s67, s65
    s_and_b32 s17, s17, 0xffff
    s_mov_b32 s24, s52
    s_and_b32 s25, s53, 0xffff
    s_mov_b32 s40, s74
    s_and_b32 s41, s75, 0xffff
    s_mov_b32 s20, s60
    s_and_b32 s21, s61, 0xffff
    s_mov_b32 s28, s68
    s_and_b32 s29, s69, 0xffff
    s_lshl_b32 s6, s2, 14
    s_lshl_b32 s7, s76, 8
    s_add_u32 s6, s6, s7
    buffer_load_dwordx4 v[192:195], v78, s[20:23], s6 offen nt
    s_add_u32 s6, s6, 0x1000
    buffer_load_dwordx4 v[196:199], v78, s[20:23], s6 offen nt
    s_add_u32 s6, s6, 0x1000
    buffer_load_dwordx4 v[200:203], v78, s[20:23], s6 offen nt
    s_add_u32 s6, s6, 0x1000
    buffer_load_dwordx4 v[204:207], v78, s[20:23], s6 offen nt
    s_cmp_lt_u32 s79, 86
    s_cbranch_scc0 L_pf_done2
    s_lshl_b32 s6, s79, 14
    s_add_u32 s6, s6, s7
    buffer_load_dwordx4 v[208:211], v78, s[28:31], s6 offen nt
    s_add_u32 s6, s6, 0x1000
    buffer_load_dwordx4 v[212:215], v78, s[28:31], s6 offen nt
    s_add_u32 s6, s6, 0x1000
    buffer_load_dwordx4 v[216:219], v78, s[28:31], s6 offen nt
    s_add_u32 s6, s6, 0x1000
    buffer_load_dwordx4 v[220:223], v78, s[28:31], s6 offen nt
L_pf_done2:
    s_cmp_lt_u32 s84, 176
    s_cbranch_scc0 L_noq
L_task:
    buffer_load_dwordx4 v[56:59], v2, s[24:27], 0 offen
    buffer_load_ushort v22, v83, s[24:27], 0 offen
    buffer_load_dwordx4 v[128:131], v76, s[16:19], s80 offen nt
    s_add_u32 s80, s80, s87
    buffer_load_dwordx4 v[132:135], v76, s[16:19], s80 offen nt
    s_add_u32 s80, s80, s87
    buffer_load_dwordx4 v[136:139], v76, s[16:19], s80 offen nt
    s_add_u32 s80, s80, s87
    buffer_load_dwordx4 v[140:143], v76, s[16:19], s80 offen nt
    s_add_u32 s80, s80, s87
    buffer_load_dwordx4 v[144:147], v76, s[16:19], s80 offen nt
    s_add_u32 s80, s80, s87
    buffer_load_dwordx4 v[148:151], v76, s[16:19], s80 offen nt
    s_add_u32 s80, s80, s87
    buffer_load_dwordx4 v[152:155], v76, s[16:19], s80 offen nt
    s_add_u32 s80, s80, s87
    buffer_load_dwordx4 v[156:159], v76, s[16:19], s80 offen nt
    s_add_u32 s80, s80, s87
    buffer_load_dwordx4 v[160:163], v76, s[16:19], s80 offen nt
    s_add_u32 s80, s80, s87
    buffer_load_dwordx4 v[164:167], v76, s[16:19], s80 offen nt
    s_add_u32 s80, s80, s87
    buffer_load_dwordx4 v[168:171], v76, s[16:19], s80 offen nt
    s_add_u32 s80, s80, s87
    buffer_load_dwordx4 v[172:175], v76, s[16:19], s80 offen nt
    s_add_u32 s80, s80, s87
    buffer_load_dwordx4 v[176:179], v76, s[16:19], s80 offen nt
    s_add_u32 s80, s80, s87
    buffer_load_dwordx4 v[180:183], v76, s[16:19], s80 offen nt
    s_add_u32 s80, s80, s87
    buffer_load_dwordx4 v[184:187], v76, s[16:19], s80 offen nt
    s_add_u32 s80, s80, s87
    buffer_load_dwordx4 v[188:191], v76, s[16:19], s80 offen nt
    s_barrier
    s_waitcnt vmcnt(16)
    s_waitcnt lgkmcnt(0)
    s_add_u32 s91, s91, 1
    s_and_b32 s92, s91, 0xff
    v_mov_b32 v14, s92
    v_lshlrev_b32 v60, 16, v56
    v_and_b32 v61, 0xffff0000, v56
    v_lshlrev_b32 v62, 16, v57
    v_and_b32 v63, 0xffff0000, v57
    v_lshlrev_b32 v64, 16, v58
    v_and_b32 v65, 0xffff0000, v58
    v_lshlrev_b32 v66, 16, v59
    v_and_b32 v67, 0xffff0000, v59
    v_add_f32 v3, v60, v61
    v_add_f32 v8, v62, v63
    v_add_f32 v9, v64, v65
    v_add_f32 v13, v66, v67
    v_add_f32 v3, v3, v8
    v_add_f32 v9, v9, v13
    v_add_f32 v3, v3, v9
    s_nop 1
    v_add_f32_dpp v3, v3, v3 row_ror:8 row_mask:0xf bank_mask:0xf
    s_nop 1
    v_add_f32_dpp v3, v3, v3 row_ror:4 row_mask:0xf bank_mask:0xf
    s_nop 1
    v_add_f32_dpp v3, v3, v3 row_ror:2 row_mask:0xf bank_mask:0xf
    s_nop 1
    v_add_f32_dpp v3, v3, v3 row_ror:1 row_mask:0xf bank_mask:0xf
    s_nop 0
    v_mov_b32 v8, v3
    s_nop 1
    v_permlane16_swap_b32 v3, v8
    s_nop 0
    v_add_f32 v3, v3, v8
    s_nop 0
    v_mov_b32 v8, v3
    s_nop 1
    v_permlane32_swap_b32 v3, v8
    s_nop 0
    v_add_f32 v3, v3, v8
    v_mul_f32 v3, 0x3b000000, v3
    v_sub_f32 v68, v60, v3
    v_sub_f32 v69, v61, v3
    v_sub_f32 v70, v62, v3
    v_sub_f32 v71, v63, v3
    v_sub_f32 v72, v64, v3
    v_sub_f32 v73, v65, v3
    v_sub_f32 v74, v66, v3
    v_sub_f32 v75, v67, v3
    v_mul_f32 v9, v68, v68
    v_fmac_f32 v9, v69, v69
    v_fmac_f32 v9, v70, v70
    v_fmac_f32 v9, v71, v71
    v_fmac_f32 v9, v72, v72
    v_fmac_f32 v9, v73, v73
    v_fmac_f32 v9, v74, v74
    v_fmac_f32 v9, v75, v75
    s_nop 1
    v_add_f32_dpp v9, v9, v9 row_ror:8 row_mask:0xf bank_mask:0xf
    s_nop 1
    v_add_f32_dpp v9, v9, v9 row_ror:4 row_mask:0xf bank_mask:0xf
    s_nop 1
    v_add_f32_dpp v9, v9, v9 row_ror:2 row_mask:0xf bank_mask:0xf
    s_nop 1
    v_add_f32_dpp v9, v9, v9 row_ror:1 row_mask:0xf bank_mask:0xf
    s_nop 0
    v_mov_b32 v8, v9
    s_nop 1
    v_permlane16_swap_b32 v9, v8
    s_nop 0
    v_add_f32 v9, v9, v8
    s_nop 0
    v_mov_b32 v8, v9
    s_nop 1
    v_permlane32_swap_b32 v9, v8
    s_nop 0
    v_add_f32 v9, v9, v8
    v_mul_f32 v9, 0x3b000000, v9
    v_cvt_pk_bf16_f32 v28, v3, v3
    v_and_b32 v28, 0xffff0000, v28
    v_cvt_pk_bf16_f32 v9, v9, v9
    v_and_b32 v9, 0xffff0000, v9
    v_add_f32 v9, 0x3727c5ac, v9
    v_cvt_pk_bf16_f32 v9, v9, v9
    v_and_b32 v9, 0xffff0000, v9
    v_sqrt_f32 v9, v9
    s_nop 0
    v_cvt_pk_bf16_f32 v29, v9, v9
    v_and_b32 v29, 0xffff0000, v29
    v_rcp_f32 v30, v29
    s_nop 0
    v_lshlrev_b32 v22, 16, v22
    v_sub_f32 v22, v22, v28
    v_cvt_pk_bf16_f32 v22, v22, v22
    v_and_b32 v22, 0xffff0000, v22
    v_mul_f32 v8, v22, v30
    v_fma_f32 v22, -v8, v29, v22
    v_fmac_f32 v8, v22, v30
    v_cvt_pk_bf16_f32 v20, v8, v8
    s_nop 1
    v_and_b32_dpp v40, v20, v16 row_newbcast:0 row_mask:0xf bank_mask:0xf
    v_and_b32_dpp v41, v20, v17 row_newbcast:0 row_mask:0xf bank_mask:0xf
    v_and_b32_dpp v42, v20, v18 row_newbcast:0 row_mask:0xf bank_mask:0xf
    v_and_b32_dpp v43, v20, v19 row_newbcast:0 row_mask:0xf bank_mask:0xf
    v_and_b32_dpp v44, v20, v16 row_newbcast:1 row_mask:0xf bank_mask:0xf
    v_and_b32_dpp v45, v20, v17 row_newbcast:1 row_mask:0xf bank_mask:0xf
    v_and_b32_dpp v46, v20, v18 row_newbcast:1 row_mask:0xf bank_mask:0xf
    v_and_b32_dpp v47, v20, v19 row_newbcast:1 row_mask:0xf bank_mask:0xf
    s_waitcnt vmcnt(12)
    v_mfma_f32_16x16x32_bf16 v[24:27], v[40:43], v[128:131], 0
    v_and_b32_dpp v48, v20, v16 row_newbcast:2 row_mask:0xf bank_mask:0xf
    v_and_b32_dpp v49, v20, v17 row_newbcast:2 row_mask:0xf bank_mask:0xf
    v_and_b32_dpp v50, v20, v18 row_newbcast:2 row_mask:0xf bank_mask:0xf
    v_and_b32_dpp v51, v20, v19 row_newbcast:2 row_mask:0xf bank_mask:0xf
    v_mfma_f32_16x16x32_bf16 v[24:27], v[44:47], v[132:135], v[24:27]
    v_and_b32_dpp v52, v20, v16 row_newbcast:3 row_mask:0xf bank_mask:0xf
    v_and_b32_dpp v53, v20, v17 row_newbcast:3 row_mask:0xf bank_mask:0xf
    v_and_b32_dpp v54, v20, v18 row_newbcast:3 row_mask:0xf bank_mask:0xf
    v_and_b32_dpp v55, v20, v19 row_newbcast:3 row_mask:0xf bank_mask:0xf
    v_mfma_f32_16x16x32_bf16 v[24:27], v[48:51], v[136:139], v[24:27]
    v_and_b32_dpp v40, v20, v16 row_newbcast:4 row_mask:0xf bank_mask:0xf
    v_and_b32_dpp v41, v20, v17 row_newbcast:4 row_mask:0xf bank_mask:0xf
    v_and_b32_dpp v42, v20, v18 row_newbcast:4 row_mask:0xf bank_mask:0xf
    v_and_b32_dpp v43, v20, v19 row_newbcast:4 row_mask:0xf bank_mask:0xf
    v_mfma_f32_16x16x32_bf16 v[24:27], v[52:55], v[140:143], v[24:27]
    v_and_b32_dpp v44, v20, v16 row_newbcast:5 row_mask:0xf bank_mask:0xf
    v_and_b32_dpp v45, v20, v17 row_newbcast:5 row_mask:0xf bank_mask:0xf
    v_and_b32_dpp v46, v20, v18 row_newbcast:5 row_mask:0xf bank_mask:0xf
    v_and_b32_dpp v47, v20, v19 row_newbcast:5 row_mask:0xf bank_mask:0xf
    s_waitcnt vmcnt(8)
    v_mfma_f32_16x16x32_bf16 v[24:27], v[40:43], v[144:147], v[24:27]
    v_and_b32_dpp v48, v20, v16 row_newbcast:6 row_mask:0xf bank_mask:0xf
    v_and_b32_dpp v49, v20, v17 row_newbcast:6 row_mask:0xf bank_mask:0xf
    v_and_b32_dpp v50, v20, v18 row_newbcast:6 row_mask:0xf bank_mask:0xf
    v_and_b32_dpp v51, v20, v19 row_newbcast:6 row_mask:0xf bank_mask:0xf
    v_mfma_f32_16x16x32_bf16 v[24:27], v[44:47], v[148:151], v[24:27]
    v_and_b32_dpp v52, v20, v16 row_newbcast:7 row_mask:0xf bank_mask:0xf
    v_and_b32_dpp v53, v20, v17 row_newbcast:7 row_mask:0xf bank_mask:0xf
    v_and_b32_dpp v54, v20, v18 row_newbcast:7 row_mask:0xf bank_mask:0xf
    v_and_b32_dpp v55, v20, v19 row_newbcast:7 row_mask:0xf bank_mask:0xf
    v_mfma_f32_16x16x32_bf16 v[24:27], v[48:51], v[152:155], v[24:27]
    v_and_b32_dpp v40, v20, v16 row_newbcast:8 row_mask:0xf bank_mask:0xf
    v_and_b32_dpp v41, v20, v17 row_newbcast:8 row_mask:0xf bank_mask:0xf
    v_and_b32_dpp v42, v20, v18 row_newbcast:8 row_mask:0xf bank_mask:0xf
    v_and_b32_dpp v43, v20, v19 row_newbcast:8 row_mask:0xf bank_mask:0xf
    v_mfma_f32_16x16x32_bf16 v[24:27], v[52:55], v[156:159], v[24:27]
    v_and_b32_dpp v44, v20, v16 row_newbcast:9 row_mask:0xf bank_mask:0xf
    v_and_b32_dpp v45, v20, v17 row_newbcast:9 row_mask:0xf bank_mask:0xf
    v_and_b32_dpp v46, v20, v18 row_newbcast:9 row_mask:0xf bank_mask:0xf
    v_and_b32_dpp v47, v20, v19 row_newbcast:9 row_mask:0xf bank_mask:0xf
    s_waitcnt vmcnt(4)
    v_mfma_f32_16x16x32_bf16 v[24:27], v[40:43], v[160:163], v[24:27]
    v_and_b32_dpp v48, v20, v16 row_newbcast:10 row_mask:0xf bank_mask:0xf
    v_and_b32_dpp v49, v20, v17 row_newbcast:10 row_mask:0xf bank_mask:0xf
    v_and_b32_dpp v50, v20, v18 row_newbcast:10 row_mask:0xf bank_mask:0xf
    v_and_b32_dpp v51, v20, v19 row_newbcast:10 row_mask:0xf bank_mask:0xf
    v_mfma_f32_16x16x32_bf16 v[24:27], v[44:47], v[164:167], v[24:27]
    v_and_b32_dpp v52, v20, v16 row_newbcast:11 row_mask:0xf bank_mask:0xf
    v_and_b32_dpp v53, v20, v17 row_newbcast:11 row_mask:0xf bank_mask:0xf
    v_and_b32_dpp v54, v20, v18 row_newbcast:11 row_mask:0xf bank_mask:0xf
    v_and_b32_dpp v55, v20, v19 row_newbcast:11 row_mask:0xf bank_mask:0xf
    v_mfma_f32_16x16x32_bf16 v[24:27], v[48:51], v[168:171], v[24:27]
    v_and_b32_dpp v40, v20, v16 row_newbcast:12 row_mask:0xf bank_mask:0xf
    v_and_b32_dpp v41, v20, v17 row_newbcast:12 row_mask:0xf bank_mask:0xf
    v_and_b32_dpp v42, v20, v18 row_newbcast:12 row_mask:0xf bank_mask:0xf
    v_and_b32_dpp v43, v20, v19 row_newbcast:12 row_mask:0xf bank_mask:0xf
    v_mfma_f32_16x16x32_bf16 v[24:27], v[52:55], v[172:175], v[24:27]
    v_and_b32_dpp v44, v20, v16 row_newbcast:13 row_mask:0xf bank_mask:0xf
    v_and_b32_dpp v45, v20, v17 row_newbcast:13 row_mask:0xf bank_mask:0xf
    v_and_b32_dpp v46, v20, v18 row_newbcast:13 row_mask:0xf bank_mask:0xf
    v_and_b32_dpp v47, v20, v19 row_newbcast:13 row_mask:0xf bank_mask:0xf
    s_waitcnt vmcnt(0)
    v_mfma_f32_16x16x32_bf16 v[24:27], v[40:43], v[176:179], v[24:27]
    v_and_b32_dpp v48, v20, v16 row_newbcast:14 row_mask:0xf bank_mask:0xf
    v_and_b32_dpp v49, v20, v17 row_newbcast:14 row_mask:0xf bank_mask:0xf
    v_and_b32_dpp v50, v20, v18 row_newbcast:14 row_mask:0xf bank_mask:0xf
    v_and_b32_dpp v51, v20, v19 row_newbcast:14 row_mask:0xf bank_mask:0xf
    v_mfma_f32_16x16x32_bf16 v[24:27], v[44:47], v[180:183], v[24:27]
    v_and_b32_dpp v52, v20, v16 row_newbcast:15 row_mask:0xf bank_mask:0xf
    v_and_b32_dpp v53, v20, v17 row_newbcast:15 row_mask:0xf bank_mask:0xf
    v_and_b32_dpp v54, v20, v18 row_newbcast:15 row_mask:0xf bank_mask:0xf
    v_and_b32_dpp v55, v20, v19 row_newbcast:15 row_mask:0xf bank_mask:0xf
    v_mfma_f32_16x16x32_bf16 v[24:27], v[48:51], v[184:187], v[24:27]
    s_nop 1
    v_mfma_f32_16x16x32_bf16 v[24:27], v[52:55], v[188:191], v[24:27]
    s_nop 7
    v_and_or_b32 v24, v24, s93, v14
    v_and_or_b32 v25, v25, s93, v14
    v_and_or_b32 v26, v26, s93, v14
    v_and_or_b32 v27, v27, s93, v14
    buffer_store_dwordx4 v[24:27], v77, s[40:43], 0 offen sc1
    s_branch L_mid
L_mid1:
    v_mov_b32 v14, s92
L_mid:
    v_lshrrev_b32 v4, 1, v12
    s_lshl_b32 s6, s76, 3
    v_add_u32 v4, s6, v4
    v_and_b32 v5, 1, v12
    v_lshlrev_b32 v5, 5, v5
    v_lshl_add_u32 v5, v11, 4, v5
    v_cmp_gt_u32_e64 s[94:95], 32, v1
    s_cmp_lt_u32 s79, 86
    s_cbranch_scc0 L_f2_done
    s_lshl_b32 s6, s79, 10
    s_add_u32 s6, s6, 0x120000
    v_add_u32 v3, s6, v2
    s_lshl_b32 s6, s79, 6
    s_add_u32 s6, s6, 0x80000
    v_lshl_add_u32 v6, v4, 13, v5
    v_add_u32 v6, s6, v6
    v_cndmask_b32_e64 v6, v10, v6, s[94:95]
    s_mov_b32 s82, 8192
L_pf:
    buffer_load_dwordx4 v[84:87], v3, s[40:43], 0 offen sc1
    s_waitcnt vmcnt(0)
    v_bitop3_b32 v7, v84, v85, s92 bitop3:0x7e
    v_bitop3_b32 v7, v7, v86, s92 bitop3:0xf6
    v_bitop3_b32 v7, v7, v87, s92 bitop3:0xf6
    v_and_b32 v7, 0xff, v7
    v_cmp_ne_u32 vcc, 0, v7
    s_cbranch_vccz L_pf_ok
    s_sleep 16
    s_sub_u32 s82, s82, 1
    s_cmp_lg_u32 s82, 0
    s_cbranch_scc1 L_pf
L_pf_ok:
    v_add_f32_dpp v84, v84, v84 row_ror:4 row_mask:0xf bank_mask:0xf
    v_add_f32_dpp v85, v85, v85 row_ror:4 row_mask:0xf bank_mask:0xf
    v_add_f32_dpp v86, v86, v86 row_ror:4 row_mask:0xf bank_mask:0xf
    v_add_f32_dpp v87, v87, v87 row_ror:4 row_mask:0xf bank_mask:0xf
    v_add_f32_dpp v84, v84, v84 row_ror:8 row_mask:0xf bank_mask:0xf
    v_add_f32_dpp v85, v85, v85 row_ror:8 row_mask:0xf bank_mask:0xf
    v_add_f32_dpp v86, v86, v86 row_ror:8 row_mask:0xf bank_mask:0xf
    v_add_f32_dpp v87, v87, v87 row_ror:8 row_mask:0xf bank_mask:0xf
    s_nop 0
    v_permlane32_swap_b32 v84, v86
    v_permlane32_swap_b32 v85, v87
    s_nop 1
    v_permlane16_swap_b32 v84, v85
    v_permlane16_swap_b32 v86, v87
    s_nop 0
    v_add_f32 v84, v84, v85
    v_add_f32 v86, v86, v87
    v_cvt_pk_bf16_f32 v84, v84, v84
    v_and_b32 v84, 0xffff0000, v84
    v_cvt_pk_bf16_f32 v86, v86, v86
    v_and_b32 v86, 0xffff0000, v86
    v_mul_f32 v7, 0xbfb8aa3b, v84
    v_exp_f32 v7, v7
    s_nop 0
    v_add_f32 v7, 1.0, v7
    v_rcp_f32 v7, v7
    s_nop 0
    v_mul_f32 v8, v84, v7
    v_cvt_pk_bf16_f32 v8, v8, v8
    v_and_b32 v8, 0xffff0000, v8
    v_mul_f32 v8, v8, v86
    v_cvt_pk_bf16_f32 v20, v8, v8
    s_nop 1
    v_and_b32_dpp v40, v20, v16 row_newbcast:0 row_mask:0xf bank_mask:0xf
    v_and_b32_dpp v41, v20, v17 row_newbcast:0 row_mask:0xf bank_mask:0xf
    v_and_b32_dpp v42, v20, v18 row_newbcast:0 row_mask:0xf bank_mask:0xf
    v_and_b32_dpp v43, v20, v19 row_newbcast:0 row_mask:0xf bank_mask:0xf
    v_and_b32_dpp v44, v20, v16 row_newbcast:1 row_mask:0xf bank_mask:0xf
    v_and_b32_dpp v45, v20, v17 row_newbcast:1 row_mask:0xf bank_mask:0xf
    v_and_b32_dpp v46, v20, v18 row_newbcast:1 row_mask:0xf bank_mask:0xf
    v_and_b32_dpp v47, v20, v19 row_newbcast:1 row_mask:0xf bank_mask:0xf
    v_and_b32_dpp v48, v20, v16 row_newbcast:2 row_mask:0xf bank_mask:0xf
    v_and_b32_dpp v49, v20, v17 row_newbcast:2 row_mask:0xf bank_mask:0xf
    v_and_b32_dpp v50, v20, v18 row_newbcast:2 row_mask:0xf bank_mask:0xf
    v_and_b32_dpp v51, v20, v19 row_newbcast:2 row_mask:0xf bank_mask:0xf
    v_and_b32_dpp v52, v20, v16 row_newbcast:3 row_mask:0xf bank_mask:0xf
    v_and_b32_dpp v53, v20, v17 row_newbcast:3 row_mask:0xf bank_mask:0xf
    v_and_b32_dpp v54, v20, v18 row_newbcast:3 row_mask:0xf bank_mask:0xf
    v_and_b32_dpp v55, v20, v19 row_newbcast:3 row_mask:0xf bank_mask:0xf
    v_mfma_f32_16x16x32_bf16 v[24:27], v[40:43], v[208:211], 0
    v_mfma_f32_16x16x32_bf16 v[24:27], v[44:47], v[212:215], v[24:27]
    v_mfma_f32_16x16x32_bf16 v[24:27], v[48:51], v[216:219], v[24:27]
    v_mfma_f32_16x16x32_bf16 v[24:27], v[52:55], v[220:223], v[24:27]
    s_nop 7
    v_and_or_b32 v24, v24, s93, v14
    v_and_or_b32 v25, v25, s93, v14
    v_and_or_b32 v26, v26, s93, v14
    v_and_or_b32 v27, v27, s93, v14
    buffer_store_dwordx4 v[24:27], v6, s[40:43], 0 offen sc1
L_f2_done:
    s_lshl_b32 s6, s2, 6
    v_lshl_add_u32 v6, v4, 14, v5
    v_add_u32 v6, s6, v6
    v_cndmask_b32_e64 v79, v10, v6, s[94:95]
    s_and_b32 s6, s77, 7
    s_cmp_eq_u32 s6, s78
    s_cselect_b32 s6, s76, 0
    s_cmp_eq_u32 s6, 1
    s_cbranch_scc0 L_prep_done
    s_lshl_b32 s6, s77, 13
    s_add_u32 s6, s6, 0x80000
    v_cmp_gt_u32 vcc, 24, v1
    v_add_u32 v3, s6, v2
    s_mov_b32 s6, 0x1000
    v_cndmask_b32 v4, v10, v3, vcc
    s_mov_b32 s82, 8192
L_py:
    buffer_load_dwordx4 v[84:87], v3, s[40:43], 0 offen offset:0 sc1
    buffer_load_dwordx4 v[88:91], v3, s[40:43], 0 offen offset:1024 sc1
    buffer_load_dwordx4 v[92:95], v3, s[40:43], 0 offen offset:2048 sc1
    buffer_load_dwordx4 v[96:99], v3, s[40:43], 0 offen offset:3072 sc1
    buffer_load_dwordx4 v[100:103], v3, s[40:43], s6 offen offset:0 sc1
    buffer_load_dwordx4 v[104:107], v4, s[40:43], s6 offen offset:1024 sc1
    s_waitcnt vmcnt(0)
    v_bitop3_b32 v5, v84, v85, s92 bitop3:0x7e
    v_bitop3_b32 v5, v5, v86, s92 bitop3:0xf6
    v_bitop3_b32 v5, v5, v87, s92 bitop3:0xf6
    v_bitop3_b32 v5, v5, v88, s92 bitop3:0xf6
    v_bitop3_b32 v5, v5, v89, s92 bitop3:0xf6
    v_bitop3_b32 v5, v5, v90, s92 bitop3:0xf6
    v_bitop3_b32 v5, v5, v91, s92 bitop3:0xf6
    v_bitop3_b32 v5, v5, v92, s92 bitop3:0xf6
    v_bitop3_b32 v5, v5, v93, s92 bitop3:0xf6
    v_bitop3_b32 v5, v5, v94, s92 bitop3:0xf6
    v_bitop3_b32 v5, v5, v95, s92 bitop3:0xf6
    v_bitop3_b32 v5, v5, v96, s92 bitop3:0xf6
    v_bitop3_b32 v5, v5, v97, s92 bitop3:0xf6
    v_bitop3_b32 v5, v5, v98, s92 bitop3:0xf6
    v_bitop3_b32 v5, v5, v99, s92 bitop3:0xf6
    v_bitop3_b32 v5, v5, v100, s92 bitop3:0xf6
    v_bitop3_b32 v5, v5, v101, s92 bitop3:0xf6
    v_bitop3_b32 v5, v5, v102, s92 bitop3:0xf6
    v_bitop3_b32 v5, v5, v103, s92 bitop3:0xf6
    s_mov_b64 exec, 0xffffff
    v_bitop3_b32 v5, v5, v104, s92 bitop3:0xf6
    v_bitop3_b32 v5, v5, v105, s92 bitop3:0xf6
    v_bitop3_b32 v5, v5, v106, s92 bitop3:0xf6
    v_bitop3_b32 v5, v5, v107, s92 bitop3:0xf6
    s_mov_b64 exec, -1
    v_and_b32 v5, 0xff, v5
    v_cmp_ne_u32 vcc, 0, v5
    s_cbranch_vccz L_py_ok
    s_sleep 24
    s_sub_u32 s82, s82, 1
    s_cmp_lg_u32 s82, 0
    s_cbranch_scc1 L_py
L_py_ok:
    v_add_f32 v84, v84, v88
    v_add_f32 v85, v85, v89
    v_add_f32 v86, v86, v90
    v_add_f32 v87, v87, v91
    v_add_f32 v84, v84, v92
    v_add_f32 v85, v85, v93
    v_add_f32 v86, v86, v94
    v_add_f32 v87, v87, v95
    v_add_f32 v84, v84, v96
    v_add_f32 v85, v85, v97
    v_add_f32 v86, v86, v98
    v_add_f32 v87, v87, v99
    v_add_f32 v84, v84, v100
    v_add_f32 v85, v85, v101
    v_add_f32 v86, v86, v102
    v_add_f32 v87, v87, v103
    v_add_f32 v84, v84, v104
    v_add_f32 v85, v85, v105
    v_add_f32 v86, v86, v106
    v_add_f32 v87, v87, v107
    s_nop 0
    v_add_f32_dpp v84, v84, v84 row_ror:4 row_mask:0xf bank_mask:0xf
    v_add_f32_dpp v85, v85, v85 row_ror:4 row_mask:0xf bank_mask:0xf
    v_add_f32_dpp v86, v86, v86 row_ror:4 row_mask:0xf bank_mask:0xf
    v_add_f32_dpp v87, v87, v87 row_ror:4 row_mask:0xf bank_mask:0xf
    v_add_f32_dpp v84, v84, v84 row_ror:8 row_mask:0xf bank_mask:0xf
    v_add_f32_dpp v85, v85, v85 row_ror:8 row_mask:0xf bank_mask:0xf
    v_add_f32_dpp v86, v86, v86 row_ror:8 row_mask:0xf bank_mask:0xf
    v_add_f32_dpp v87, v87, v87 row_ror:8 row_mask:0xf bank_mask:0xf
    s_nop 0
    v_permlane32_swap_b32 v84, v86
    v_permlane32_swap_b32 v85, v87
    s_nop 0
    v_add_f32 v84, v84, v86
    v_add_f32 v85, v85, v87
    s_nop 1
    v_permlane16_swap_b32 v84, v85
    s_nop 0
    v_add_f32 v84, v84, v85
    v_cvt_pk_bf16_f32 v84, v84, v84
    v_and_b32 v84, 0xffff0000, v84
    v_mul_f32 v4, 0xbfb8aa3b, v84
    v_exp_f32 v4, v4
    s_nop 0
    v_add_f32 v4, 1.0, v4
    v_rcp_f32 v4, v4
    s_nop 0
    v_mul_f32 v5, v84, v4
    v_cvt_pk_bf16_f32 v5, v5, v5
    v_and_b32 v5, 0xffff0000, v5
    v_and_b32 v3, 3, v12
    v_lshlrev_b32 v3, 4, v3
    v_lshl_add_u32 v3, v11, 2, v3
    s_mov_b32 exec_lo, 0x000f000f
    s_mov_b32 exec_hi, 0x000f000f
    ds_write_b32 v3, v5 offset:2592
    s_mov_b64 exec, -1
L_prep_done:
    s_lshl_b32 s6, s77, 13
    s_add_u32 s6, s6, 0x140000
    v_lshrrev_b32 v3, 2, v1
    v_and_b32 v4, 3, v1
    v_lshlrev_b32 v4, 4, v4
    v_lshl_add_u32 v5, v3, 10, v4
    s_lshl_b32 s7, s78, 6
    s_add_u32 s7, s7, s6
    v_add_u32 v5, s7, v5
    v_subrev_u32 v6, 32, v1
    v_cmp_gt_u32 vcc, 8, v6
    v_lshlrev_b32 v7, 10, v6
    s_lshl_b32 s7, s78, 4
    s_add_u32 s7, s7, s6
    s_add_u32 s7, s7, 512
    v_add_u32 v7, s7, v7
    v_cndmask_b32 v7, v10, v7, vcc
    v_cndmask_b32_e64 v80, v7, v5, s[94:95]
    s_lshl_b32 s7, s78, 10
    s_add_u32 s7, s7, s6
    v_and_b32 v3, 7, v3
    v_lshl_add_u32 v5, v3, 6, v4
    v_add_u32 v81, s7, v5
    s_add_u32 s7, s7, 512
    v_lshlrev_b32 v5, 4, v3
    v_add_u32 v82, s7, v5
    v_and_b32 v3, 31, v1
    v_lshlrev_b32 v3, 4, v3
    v_mov_b32 v4, 2560
    s_mov_b32 s82, 8192
    s_waitcnt vmcnt(0) lgkmcnt(0)
    s_cmp_eq_u32 s76, 3
    s_cbranch_scc0 L_dp_done
    s_lshl_b32 s6, s77, 12
    s_add_u32 s6, s6, 0x180000
    v_mov_b32 v42, s6
    v_mov_b32 v43, 0
    s_movk_i32 s99, 2048
    s_bitcmp1_b32 s78, 0
    s_cselect_b32 s99, 2016, s99
    s_mov_b32 s96, 0
    s_mov_b32 s97, 8
    s_mov_b32 s98, 0x40000
    s_mov_b64 exec, 1
    v_mov_b32 v44, 8
    buffer_atomic_add v44, v42, s[40:43], 0 offen sc0 sc1
L_dp:
    s_waitcnt vmcnt(0)
    v_add_u32 v44, 1664, v44
    v_mov_b32 v41, s96
    ds_write_b32 v41, v44 offset:3136
    s_add_u32 s96, s96, 4
    v_readfirstlane_b32 s6, v44
    s_cmp_ge_u32 s6, s99
    s_cbranch_scc1 L_dp_fin0
L_dp_thr0:
    ds_read_b32 v40, v43 offset:3072
    s_waitcnt lgkmcnt(0)
    v_readfirstlane_b32 s7, v40
    s_sub_u32 s7, s97, s7
    s_cmp_lt_i32 s7, 7
    s_cbranch_scc1 L_dp_go0
    s_sleep 1
    s_sub_u32 s98, s98, 1
    s_cbranch_scc0 L_dp_thr0
    s_branch L_dp_fin0
L_dp_go0:
    v_mov_b32 v44, 8
    buffer_atomic_add v44, v42, s[40:43], 0 offen sc0 sc1
    s_add_u32 s97, s97, 8
    s_branch L_dp
L_dp_fin0:
    s_waitcnt vmcnt(0)
L_dp_end:
    s_mov_b64 exec, 0xff
    v_lshl_add_u32 v41, v1, 2, s96
    v_mov_b32 v40, 0x1000
    ds_write_b32 v41, v40 offset:3136
    s_mov_b64 exec, -1
    s_waitcnt lgkmcnt(0)
L_dp_done:
    s_barrier
    s_cmp_eq_u32 s76, 0
    s_cbranch_scc0 L_po
    ds_read_b128 v[32:35], v4
    ds_read_b128 v[36:39], v4 offset:16
    ds_read_b128 v[40:43], v3 offset:512
    ds_read_b128 v[44:47], v3 offset:1024
    ds_read_b128 v[48:51], v3 offset:1536
    ds_read_b128 v[52:55], v3 offset:2048
    s_waitcnt lgkmcnt(4)
    v_max3_f32 v6, v32, v34, v36
    v_max_f32 v6, v6, v38
    v_and_or_b32 v7, v6, s93, v14
    v_sub_f32 v8, v6, v7
    v_and_or_b32 v8, v8, s93, v14
    v_add_f32 v6, v7, v8
    v_sub_f32 v32, v32, v6
    v_sub_f32 v34, v34, v6
    v_sub_f32 v36, v36, v6
    v_sub_f32 v38, v38, v6
    v_exp_f32 v32, v32
    v_exp_f32 v34, v34
    v_exp_f32 v36, v36
    v_exp_f32 v38, v38
    s_waitcnt lgkmcnt(0)
    v_mul_f32 v24, v32, v40
    v_mul_f32 v25, v32, v41
    v_mul_f32 v26, v32, v42
    v_mul_f32 v27, v32, v43
    v_mul_f32 v9, v32, v33
    v_fmac_f32 v24, v34, v44
    v_fmac_f32 v25, v34, v45
    v_fmac_f32 v26, v34, v46
    v_fmac_f32 v27, v34, v47
    v_fmac_f32 v9, v34, v35
    v_fmac_f32 v24, v36, v48
    v_fmac_f32 v25, v36, v49
    v_fmac_f32 v26, v36, v50
    v_fmac_f32 v27, v36, v51
    v_fmac_f32 v9, v36, v37
    v_fmac_f32 v24, v38, v52
    v_fmac_f32 v25, v38, v53
    v_fmac_f32 v26, v38, v54
    v_fmac_f32 v27, v38, v55
    v_fmac_f32 v9, v38, v39
    v_and_or_b32 v24, v24, s93, v14
    v_and_or_b32 v25, v25, s93, v14
    v_and_or_b32 v26, v26, s93, v14
    v_and_or_b32 v27, v27, s93, v14
    v_and_or_b32 v9, v9, s93, v14
    v_cndmask_b32_e64 v24, v7, v24, s[94:95]
    v_cndmask_b32_e64 v25, v9, v25, s[94:95]
    v_cndmask_b32_e64 v26, v8, v26, s[94:95]
    v_cndmask_b32_e64 v27, v9, v27, s[94:95]
    buffer_store_dwordx4 v[24:27], v80, s[40:43], 0 offen sc1
L_po:
    buffer_load_dwordx4 v[84:87], v81, s[40:43], 0 offen sc1
    buffer_load_dwordx4 v[88:91], v82, s[40:43], 0 offen sc1
    s_waitcnt vmcnt(0)
    v_bitop3_b32 v5, v84, v85, s92 bitop3:0x7e
    v_bitop3_b32 v5, v5, v86, s92 bitop3:0xf6
    v_bitop3_b32 v5, v5, v87, s92 bitop3:0xf6
    v_bitop3_b32 v5, v5, v88, s92 bitop3:0xf6
    v_bitop3_b32 v5, v5, v89, s92 bitop3:0xf6
    v_bitop3_b32 v5, v5, v90, s92 bitop3:0xf6
    v_bitop3_b32 v5, v5, v91, s92 bitop3:0xf6
    v_and_b32 v5, 0xff, v5
    v_cmp_ne_u32 vcc, 0, v5
    s_cbranch_vccz L_po_ok
    s_sub_u32 s82, s82, 1
    s_cmp_lg_u32 s82, 0
    s_cbranch_scc1 L_po
L_po_ok:
    v_add_f32 v88, v88, v90
    v_mov_b32 v6, v88
    s_nop 1
    v_max_f32_dpp v6, v6, v6 row_ror:4 row_mask:0xf bank_mask:0xf
    s_nop 1
    v_max_f32_dpp v6, v6, v6 row_ror:8 row_mask:0xf bank_mask:0xf
    s_nop 0
    v_mov_b32 v8, v6
    s_nop 1
    v_permlane16_swap_b32 v6, v8
    s_nop 0
    v_max_f32 v6, v6, v8
    v_sub_f32 v6, v88, v6
    v_exp_f32 v6, v6
    s_nop 0
    v_mul_f32 v7, v6, v89
    s_nop 1
    v_add_f32_dpp v7, v7, v7 row_ror:4 row_mask:0xf bank_mask:0xf
    s_nop 1
    v_add_f32_dpp v7, v7, v7 row_ror:8 row_mask:0xf bank_mask:0xf
    s_nop 0
    v_mov_b32 v8, v7
    s_nop 1
    v_permlane16_swap_b32 v7, v8
    s_nop 0
    v_add_f32 v7, v7, v8
    v_add_f32 v7, v7, v7
    v_rcp_f32 v7, v7
    s_nop 0
    v_mul_f32 v6, v6, v7
    v_mul_f32 v84, v6, v84
    v_mul_f32 v85, v6, v85
    v_mul_f32 v86, v6, v86
    v_mul_f32 v87, v6, v87
    s_nop 0
    v_add_f32_dpp v84, v84, v84 row_ror:4 row_mask:0xf bank_mask:0xf
    v_add_f32_dpp v85, v85, v85 row_ror:4 row_mask:0xf bank_mask:0xf
    v_add_f32_dpp v86, v86, v86 row_ror:4 row_mask:0xf bank_mask:0xf
    v_add_f32_dpp v87, v87, v87 row_ror:4 row_mask:0xf bank_mask:0xf
    v_add_f32_dpp v84, v84, v84 row_ror:8 row_mask:0xf bank_mask:0xf
    v_add_f32_dpp v85, v85, v85 row_ror:8 row_mask:0xf bank_mask:0xf
    v_add_f32_dpp v86, v86, v86 row_ror:8 row_mask:0xf bank_mask:0xf
    v_add_f32_dpp v87, v87, v87 row_ror:8 row_mask:0xf bank_mask:0xf
    s_nop 0
    v_permlane32_swap_b32 v84, v86
    v_permlane32_swap_b32 v85, v87
    s_nop 0
    v_add_f32 v84, v84, v86
    v_add_f32 v85, v85, v87
    s_nop 1
    v_permlane16_swap_b32 v84, v85
    s_nop 0
    v_add_f32 v84, v84, v85
    v_cvt_pk_bf16_f32 v20, v84, v84
    s_nop 1
    v_and_b32_dpp v40, v20, v16 row_newbcast:0 row_mask:0xf bank_mask:0xf
    v_and_b32_dpp v41, v20, v17 row_newbcast:0 row_mask:0xf bank_mask:0xf
    v_and_b32_dpp v42, v20, v18 row_newbcast:0 row_mask:0xf bank_mask:0xf
    v_and_b32_dpp v43, v20, v19 row_newbcast:0 row_mask:0xf bank_mask:0xf
    v_and_b32_dpp v44, v20, v16 row_newbcast:1 row_mask:0xf bank_mask:0xf
    v_and_b32_dpp v45, v20, v17 row_newbcast:1 row_mask:0xf bank_mask:0xf
    v_and_b32_dpp v46, v20, v18 row_newbcast:1 row_mask:0xf bank_mask:0xf
    v_and_b32_dpp v47, v20, v19 row_newbcast:1 row_mask:0xf bank_mask:0xf
    v_and_b32_dpp v48, v20, v16 row_newbcast:2 row_mask:0xf bank_mask:0xf
    v_and_b32_dpp v49, v20, v17 row_newbcast:2 row_mask:0xf bank_mask:0xf
    v_and_b32_dpp v50, v20, v18 row_newbcast:2 row_mask:0xf bank_mask:0xf
    v_and_b32_dpp v51, v20, v19 row_newbcast:2 row_mask:0xf bank_mask:0xf
    v_and_b32_dpp v52, v20, v16 row_newbcast:3 row_mask:0xf bank_mask:0xf
    v_and_b32_dpp v53, v20, v17 row_newbcast:3 row_mask:0xf bank_mask:0xf
    v_and_b32_dpp v54, v20, v18 row_newbcast:3 row_mask:0xf bank_mask:0xf
    v_and_b32_dpp v55, v20, v19 row_newbcast:3 row_mask:0xf bank_mask:0xf
    v_mfma_f32_16x16x32_bf16 v[24:27], v[40:43], v[192:195], 0
    v_mfma_f32_16x16x32_bf16 v[24:27], v[44:47], v[196:199], v[24:27]
    v_mfma_f32_16x16x32_bf16 v[24:27], v[48:51], v[200:203], v[24:27]
    v_mfma_f32_16x16x32_bf16 v[24:27], v[52:55], v[204:207], v[24:27]
    s_nop 7
    v_and_or_b32 v24, v24, s93, v14
    v_and_or_b32 v25, v25, s93, v14
    v_and_or_b32 v26, v26, s93, v14
    v_and_or_b32 v27, v27, s93, v14
    buffer_store_dwordx4 v[24:27], v79, s[40:43], 0 offen sc1
L_exit:
L_end:
    s_endpgm
L_dyn2x:
    s_movk_i32 s6, 0x1000
    s_cmp_lg_u32 s90, 0
    s_cbranch_scc1 L_got2x
    s_mov_b64 exec, 1
    ds_add_rtn_u32 v10, v14, v13 offset:3072
    s_waitcnt lgkmcnt(0)
    v_lshrrev_b32 v8, 3, v10
    v_lshlrev_b32 v8, 2, v8
L_dsp2x:
    ds_read_b32 v5, v8 offset:3136
    v_readfirstlane_b32 s7, v10
    s_waitcnt lgkmcnt(0)
    v_readfirstlane_b32 s6, v5
    s_and_b32 s7, s7, 7
    s_cmp_eq_u32 s6, -1
    s_cbranch_scc1 L_dwt2x
    s_add_u32 s6, s6, s7
    s_mov_b64 exec, -1
    s_branch L_got2x
L_dwt2x:
    s_sleep 1
    s_sub_u32 s82, s82, 1
    s_cbranch_scc0 L_dsp2x
    s_mov_b32 s82, 0
    s_movk_i32 s6, 0x1000
    s_mov_b64 exec, -1
    s_branch L_got2x
L_dyn3x:
    s_movk_i32 s6, 0x1000
    s_cmp_lg_u32 s90, 0
    s_cbranch_scc1 L_got3x
    s_mov_b64 exec, 1
    ds_add_rtn_u32 v10, v14, v13 offset:3072
    s_waitcnt lgkmcnt(0)
    v_lshrrev_b32 v8, 3, v10
    v_lshlrev_b32 v8, 2, v8
L_dsp3x:
    ds_read_b32 v5, v8 offset:3136
    v_readfirstlane_b32 s7, v10
    s_waitcnt lgkmcnt(0)
    v_readfirstlane_b32 s6, v5
    s_and_b32 s7, s7, 7
    s_cmp_eq_u32 s6, -1
    s_cbranch_scc1 L_dwt3x
    s_add_u32 s6, s6, s7
    s_mov_b64 exec, -1
    s_branch L_got3x
L_dwt3x:
    s_sleep 1
    s_sub_u32 s82, s82, 1
    s_cbranch_scc0 L_dsp3x
    s_mov_b32 s82, 0
    s_movk_i32 s6, 0x1000
    s_mov_b64 exec, -1
    s_branch L_got3x
L_dyn2:
    s_movk_i32 s6, 0x1000
    s_cmp_lg_u32 s90, 0
    s_cbranch_scc1 L_got2
    s_mov_b64 exec, 1
    ds_add_rtn_u32 v10, v14, v13 offset:3072
    s_waitcnt lgkmcnt(0)
    v_lshrrev_b32 v8, 3, v10
    v_lshlrev_b32 v8, 2, v8
L_dsp2:
    ds_read_b32 v5, v8 offset:3136
    v_readfirstlane_b32 s7, v10
    s_waitcnt lgkmcnt(0)
    v_readfirstlane_b32 s6, v5
    s_and_b32 s7, s7, 7
    s_cmp_eq_u32 s6, -1
    s_cbranch_scc1 L_dwt2
    s_add_u32 s6, s6, s7
    s_mov_b64 exec, -1
    s_branch L_got2
L_dwt2:
    s_sleep 1
    s_sub_u32 s82, s82, 1
    s_cbranch_scc0 L_dsp2
    s_mov_b32 s82, 0
    s_movk_i32 s6, 0x1000
    s_mov_b64 exec, -1
    s_branch L_got2
L_resc_2:
    v_mov_b32 v31, v33
    s_nop 1
    v_max_f32_dpp v31, v31, v31 row_ror:4 row_mask:0xf bank_mask:0xf
    s_nop 1
    v_max_f32_dpp v31, v31, v31 row_ror:8 row_mask:0xf bank_mask:0xf
    s_nop 0
    v_mov_b32 v3, v31
    s_nop 1
    v_permlane16_swap_b32 v31, v3
    s_nop 0
    v_max_f32 v31, v31, v3
    s_nop 0
    v_mov_b32 v3, v31
    s_nop 1
    v_permlane32_swap_b32 v31, v3
    s_nop 0
    v_max_f32 v31, v31, v3
    v_max_f32 v31, v31, v28
    v_sub_f32 v3, v28, v31
    v_mul_f32 v3, s83, v3
    v_exp_f32 v3, v3
    v_mov_b32 v28, v31
    v_mul_f32 v29, s83, v31
    v_mul_f32 v24, v24, v3
    v_mul_f32 v25, v25, v3
    v_mul_f32 v26, v26, v3
    v_mul_f32 v27, v27, v3
    v_mul_f32 v30, v30, v3
    v_fma_f32 v36, v33, s83, -v29
    s_branch L_back_2
L_dyn3:
    s_movk_i32 s6, 0x1000
    s_cmp_lg_u32 s90, 0
    s_cbranch_scc1 L_got3
    s_mov_b64 exec, 1
    ds_add_rtn_u32 v10, v14, v13 offset:3072
    s_waitcnt lgkmcnt(0)
    v_lshrrev_b32 v8, 3, v10
    v_lshlrev_b32 v8, 2, v8
L_dsp3:
    ds_read_b32 v5, v8 offset:3136
    v_readfirstlane_b32 s7, v10
    s_waitcnt lgkmcnt(0)
    v_readfirstlane_b32 s6, v5
    s_and_b32 s7, s7, 7
    s_cmp_eq_u32 s6, -1
    s_cbranch_scc1 L_dwt3
    s_add_u32 s6, s6, s7
    s_mov_b64 exec, -1
    s_branch L_got3
L_dwt3:
    s_sleep 1
    s_sub_u32 s82, s82, 1
    s_cbranch_scc0 L_dsp3
    s_mov_b32 s82, 0
    s_movk_i32 s6, 0x1000
    s_mov_b64 exec, -1
    s_branch L_got3
L_resc_3:
    v_mov_b32 v31, v33
    s_nop 1
    v_max_f32_dpp v31, v31, v31 row_ror:4 row_mask:0xf bank_mask:0xf
    s_nop 1
    v_max_f32_dpp v31, v31, v31 row_ror:8 row_mask:0xf bank_mask:0xf
    s_nop 0
    v_mov_b32 v3, v31
    s_nop 1
    v_permlane16_swap_b32 v31, v3
    s_nop 0
    v_max_f32 v31, v31, v3
    s_nop 0
    v_mov_b32 v3, v31
    s_nop 1
    v_permlane32_swap_b32 v31, v3
    s_nop 0
    v_max_f32 v31, v31, v3
    v_max_f32 v31, v31, v28
    v_sub_f32 v3, v28, v31
    v_mul_f32 v3, s83, v3
    v_exp_f32 v3, v3
    v_mov_b32 v28, v31
    v_mul_f32 v29, s83, v31
    v_mul_f32 v24, v24, v3
    v_mul_f32 v25, v25, v3
    v_mul_f32 v26, v26, v3
    v_mul_f32 v27, v27, v3
    v_mul_f32 v30, v30, v3
    v_fma_f32 v36, v33, s83, -v29
    s_branch L_back_3
L_codeend:
.section .rodata,"a"
.p2align 6
.amdhsa_kernel recurrent_scan__mha_block_cached__swiglu_ffn__decode_kernel
  .amdhsa_next_free_vgpr 256
  .amdhsa_next_free_sgpr 102
  .amdhsa_accum_offset 256
  .amdhsa_group_segment_fixed_size 0
  .amdhsa_kernarg_size 96
  .amdhsa_user_sgpr_count 2
  .amdhsa_user_sgpr_kernarg_segment_ptr 1
  .amdhsa_system_sgpr_workgroup_id_x 1
.end_amdhsa_kernel
```
